```python
import torch

def _softmax(x, axis=-1):
    return torch.softmax(x, dim=axis)

def _gelu(x):
    return torch.nn.functional.gelu(x, approximate='tanh')

def _silu(x):
    return torch.nn.functional.silu(x)

def _sigmoid(x):
    return torch.sigmoid(x)

def _layernorm(x, axis=-1, eps=1e-05):
    m = x.mean(dim=axis, keepdim=True)
    v = x.var(dim=axis, keepdim=True, unbiased=False)
    return (x - m) / torch.sqrt(v + eps)

def _scatter_add(tgt, idx, src, axis=0):
    return tgt.clone().index_add_(axis, idx, src)

def _segment_sum(src, seg, n):
    out = torch.zeros((n,) + src.shape[1:], dtype=src.dtype)
    return out.index_add_(0, seg, src)

def _pad(x, pw):
    flat = tuple((v for pair in reversed(pw) for v in pair))
    return torch.nn.functional.pad(x, flat)
kernel_name = 'adaLN_cond__gqa_block_cached__glu_gated_swiglu__decode'

def setup_inputs():

    _w = lambda a: (lambda t: t.to(torch.bfloat16) if t.is_floating_point() else t)(torch.as_tensor(a))

    def _A_setup():
        B, Sq, D = (2, 1, 576)
        Hq, Hkv, Sk, Dh = (32, 16, 8192, 128)
        assert Hq % Hkv == 0, (Hq, Hkv)
        return {'x': _w((lambda *s: torch.randn(*s, dtype=torch.bfloat16) * 0.1)(B, Sq, D)), 'k_cache': _w((lambda *s: torch.randn(*s, dtype=torch.bfloat16) * 0.8)(B, Hkv, Sk, Dh)), 'v_cache': _w((lambda *s: torch.randn(*s, dtype=torch.bfloat16) * 3.2)(B, Hkv, Sk, Dh)), 'wq': _w((lambda *s: torch.randn(*s, dtype=torch.bfloat16) * 0.8)(D, Hq * Dh) * D ** (-0.5)), 'wo': _w((lambda *s: torch.randn(*s, dtype=torch.bfloat16) * 3.2)(Hq * Dh, D) * (Hq * Dh) ** (-0.5))}
    _A_in = _A_setup()

    def _B_setup():
        B, S, D, F = (2, 1, 576, 4608)
        return {'x': _w((lambda *s: torch.randn(*s, dtype=torch.bfloat16) * 0.1)(B, S, D)), 'w1': _w((lambda *s: torch.randn(*s, dtype=torch.bfloat16) * 3.2)(D, F) * (2.0 / D) ** 0.5), 'w3': _w((lambda *s: torch.randn(*s, dtype=torch.bfloat16) * 3.2)(D, F) * (2.0 / D) ** 0.5), 'w2': _w((lambda *s: torch.randn(*s, dtype=torch.bfloat16) * 3.2)(F, D) * (2.0 / F) ** 0.5)}
    _B_in = _B_setup()
    return {'A_x': _A_in['x'], 'A_k_cache': _A_in['k_cache'], 'A_v_cache': _A_in['v_cache'], 'A_wq': _A_in['wq'], 'A_wo': _A_in['wo'], 'B_x': _B_in['x'], 'B_w1': _B_in['w1'], 'B_w3': _B_in['w3'], 'B_w2': _B_in['w2'], 'c': _w((lambda *s: torch.randn(*s, dtype=torch.bfloat16) * 0.4)(2, 576) * 8.0), 'w_mod': _w((lambda *s: torch.randn(*s, dtype=torch.bfloat16) * 0.4)(576, 6 * 576) * 576 ** (-0.5) * 8.0)}

def reference(A_x, A_k_cache, A_v_cache, A_wq, A_wo, B_x, B_w1, B_w3, B_w2, c, w_mod):

    def _A_ref(x, k_cache, v_cache, wq, wo):
        B, Sq, D = x.shape
        Hq, Dh = (32, 128)
        Hkv = k_cache.shape[1]
        rep = Hq // Hkv
        q = (lambda x, *d: x.permute(*d))((x @ wq).reshape(B, Sq, Hq, Dh), 0, 2, 1, 3)
        k = (lambda x, n, axis: torch.repeat_interleave(x, n, dim=axis))(k_cache, rep, axis=1)
        v = (lambda x, n, axis: torch.repeat_interleave(x, n, dim=axis))(v_cache, rep, axis=1)
        scores = torch.einsum('bhqd,bhkd->bhqk', q, k) * Dh ** (-0.5)
        p = _softmax(scores, axis=-1)
        o = torch.einsum('bhqk,bhkd->bhqd', p, v)
        return (lambda x, *d: x.permute(*d))(o, 0, 2, 1, 3).reshape(B, Sq, Hq * Dh) @ wo

    def _B_ref(x, w1, w3, w2):
        gate = torch.einsum('bsd,df->bsf', x, w1)
        up = torch.einsum('bsd,df->bsf', x, w3)
        h = _silu(gate) * up
        out = torch.einsum('bsf,fd->bsd', h, w2)
        return out
    x = A_x
    mod = (_silu(c) @ w_mod).reshape(c.shape[0], 6, 1, -1)
    sa, ca, ga, sb, cb, gb = (mod[:, 0].clone(), mod[:, 1].clone(), mod[:, 2].clone(), mod[:, 3].clone(), mod[:, 4].clone(), mod[:, 5].clone())
    h = _layernorm(x, axis=-1) * (1 + ca) + sa
    x = x + ga * _A_ref(h, A_k_cache, A_v_cache, A_wq, A_wo)
    h = _layernorm(x, axis=-1) * (1 + cb) + sb
    x = x + gb * _B_ref(h, B_w1, B_w3, B_w2)
    return x
```

```asm
; @launch grid=(256,1,1) block=(768,1,1) lds=163840
.amdgcn_target "amdgcn-amd-amdhsa--gfx950"
.text
.globl adaLN_cond__gqa_block_cached__glu_gated_swiglu__decode_kernel
.p2align 8
.type adaLN_cond__gqa_block_cached__glu_gated_swiglu__decode_kernel,@function
adaLN_cond__gqa_block_cached__glu_gated_swiglu__decode_kernel:
L_code0:
    s_load_dwordx16 s[36:51], s[0:1], 0
    s_load_dwordx8 s[52:59], s[0:1], 64
    s_load_dwordx4 s[60:63], s[0:1], 96
    s_cmp_ge_u32 s2, 256
    s_cbranch_scc1 L_exit
    v_lshrrev_b32 v1, 6, v0
    v_and_b32 v0, 63, v0
    v_readfirstlane_b32 s3, v1
    s_and_b32 s4, s2, 7
    s_lshr_b32 s5, s2, 3
    s_sub_u32 s22, s2, 88
    s_cmp_lt_u32 s22, 32
    s_cselect_b32 s21, 2, 0
    s_sub_u32 s28, s5, 19
    s_cmp_lt_u32 s28, 8
    s_cselect_b32 s21, 3, s21
    s_cmp_ge_u32 s3, 8
    s_cbranch_scc1 L_service
    v_and_b32 v3, 3, v0
    v_lshrrev_b32 v4, 4, v0
    v_lshl_add_u32 v3, v4, 2, v3
    s_and_b32 s28, s5, 16
    s_lshl_b32 s29, s4, 1
    s_add_u32 s28, s28, s29
    s_lshl_b32 s28, s28, 3
    s_and_b32 s29, s5, 15
    s_add_u32 s28, s28, s29
    s_lshl_b32 s33, s28, 18
    s_bfe_u32 s32, s3, 196608
    s_mul_i32 s32, s32, 4096
    s_bfe_u32 s30, s5, 65536
    s_mul_i32 s30, s30, 33792
    s_xor_b32 s32, s32, s30
    s_bfe_u32 s30, s5, 65537
    s_mul_i32 s30, s30, 231424
    s_xor_b32 s32, s32, s30
    s_bfe_u32 s30, s5, 65538
    s_mul_i32 s30, s30, 33792
    s_xor_b32 s32, s32, s30
    v_lshlrev_b32 v2, 4, v3
    v_bfe_u32 v4, v0, 2, 2
    v_mul_u32_u24 v4, 256, v4
    v_xor_b32 v2, v2, v4
    v_xor_b32 v2, s32, v2
    s_mov_b32 s10, 67108864
    s_mov_b32 s11, 0x20000
    s_waitcnt lgkmcnt(0)
    s_mov_b32 s8, s38
    s_mov_b32 s9, s39
L_k0:
    buffer_load_dwordx4 v[40:43], v2, s[8:11], s33 offen nt
    v_xor_b32 v2, 67584, v2
    buffer_load_dwordx4 v[44:47], v2, s[8:11], s33 offen nt
    v_xor_b32 v2, 99328, v2
    buffer_load_dwordx4 v[48:51], v2, s[8:11], s33 offen nt
    v_xor_b32 v2, 67584, v2
    buffer_load_dwordx4 v[52:55], v2, s[8:11], s33 offen nt
    v_xor_b32 v2, 34816, v2
    s_branch L_stream
L_service:
    v_mov_b32 v1, 0
    s_sub_u32 s3, s3, 8
    s_getpc_b64 s[12:13]
L_pc0:
    s_sub_u32 s12, s12, L_pc0-L_code0
    s_subb_u32 s13, s13, 0
    s_mov_b32 s14, L_exit-L_code0
    s_mov_b32 s15, 0x20000
    s_lshl_b32 s28, s5, 2
    s_add_u32 s28, s28, s3
    s_lshl_b32 s28, s28, 8
    v_lshlrev_b32 v2, 2, v0
    buffer_load_dword v95, v2, s[12:15], s28 offen
    s_mov_b64 exec, 0xffff
    ds_write_b32 v2, v1
    s_mov_b64 exec, -1
    s_sub_u32 s28, s2, 216
    s_add_u32 s29, s28, 32
    s_cmp_lt_u32 s28, 22
    s_cselect_b32 s21, 2, s21
    s_cselect_b32 s22, s29, s22
    s_cmp_lg_u32 s21, 0
    s_cbranch_scc1 L_job
    s_mov_b32 s20, 1152
    v_lshrrev_b32 v2, 3, v0
    v_mul_lo_u32 v2, v2, s20
    v_and_b32 v3, 7, v0
    v_bfe_u32 v4, v0, 4, 1
    v_lshlrev_b32 v4, 1, v4
    v_xor_b32 v3, v3, v4
    v_xor_b32 v4, 4, v3
    v_lshl_add_u32 v3, v3, 4, v2
    v_lshl_add_u32 v4, v4, 4, v2
    s_lshl_b32 s17, s20, 3
    s_lshl_b32 s28, s4, 2
    s_add_u32 s28, s28, s3
    s_sub_u32 s30, s5, 15
    s_cmp_lt_u32 s5, 9
    s_cselect_b32 s19, 8, 9
    s_cselect_b32 s30, s5, s30
    s_mov_b32 s29, 90112
    s_cselect_b32 s29, 16384, s29
    s_mul_i32 s16, s19, 18432
    s_lshl_b32 s10, s16, 5
    s_mul_i32 s16, s16, s28
    s_lshl_b32 s30, s30, 7
    s_add_u32 s16, s16, s30
    s_lshl_b32 s30, s19, 11
    s_mul_i32 s30, s30, s3
    s_add_u32 s29, s29, s30
    s_mov_b32 s11, 0x20000
    s_waitcnt lgkmcnt(0)
    s_cmp_lt_u32 s5, 9
    s_cselect_b32 s8, s44, s52
    s_cselect_b32 s9, s45, s53
    s_cmp_ge_u32 s5, 27
    s_cbranch_scc1 L_noearly
    s_sub_u32 s28, s5, 9
    s_cmp_lt_u32 s28, 2
    s_cbranch_scc1 L_noearly
L_dma_early:
    s_mov_b32 m0, s29
    s_add_u32 s29, s29, 1024
    buffer_load_dwordx4 v3, s[8:11], s16 offen nt lds
    s_add_u32 s16, s16, s17
    s_mov_b32 m0, s29
    s_add_u32 s29, s29, 1024
    buffer_load_dwordx4 v4, s[8:11], s16 offen nt lds
    s_add_u32 s16, s16, s17
    s_sub_u32 s19, s19, 1
    s_cmp_lg_u32 s19, 0
    s_cbranch_scc1 L_dma_early
L_noearly:
    s_load_dword s34, s[62:63], 786432
    s_mov_b32 s24, s62
    s_mov_b32 s25, s63
    s_mov_b32 s26, 2097152
    s_mov_b32 s27, 0x20000
    s_barrier
    s_branch L_roles
L_job:
    s_cmp_eq_u32 s21, 3
    s_mov_b32 s20, 6912
    s_cselect_b32 s20, 8192, s20
    v_lshrrev_b32 v2, 3, v0
    v_mul_lo_u32 v2, v2, s20
    v_and_b32 v3, 7, v0
    v_bfe_u32 v4, v0, 4, 1
    v_lshlrev_b32 v4, 1, v4
    v_xor_b32 v3, v3, v4
    v_xor_b32 v4, 4, v3
    v_lshl_add_u32 v3, v3, 4, v2
    v_lshl_add_u32 v4, v4, 4, v2
    s_lshl_b32 s17, s20, 3
    v_and_b32 v8, 31, v0
    v_min_u32 v9, 7, v8
    s_mul_i32 s28, s3, 72
    v_add_u32 v8, s28, v8
    s_add_u32 s28, s28, 64
    v_add_u32 v9, s28, v9
    v_lshrrev_b32 v11, 5, v0
    v_mul_u32_u24 v11, 1152, v11
    v_lshl_add_u32 v10, v8, 2, v11
    v_lshl_add_u32 v11, v9, 2, v11
    s_lshl_b32 s28, s4, 3
    s_sub_u32 s29, s5, 19
    s_add_u32 s28, s28, s29
    s_cmp_eq_u32 s21, 3
    s_cselect_b32 s22, s28, s22
    s_mul_i32 s10, s20, 576
    s_mov_b32 s11, 0x20000
    s_mul_i32 s16, s20, 144
    s_mul_i32 s16, s16, s3
    s_lshl_b32 s28, s22, 7
    s_add_u32 s16, s16, s28
    s_mul_i32 s29, s3, 18432
    s_add_u32 s29, s29, 90112
    s_mov_b32 s19, 9
    s_mov_b32 s14, 2304
    s_mov_b32 s15, 0x20000
    s_waitcnt lgkmcnt(0)
    s_cmp_eq_u32 s21, 3
    s_cselect_b32 s8, s42, s56
    s_cselect_b32 s9, s43, s57
    s_cselect_b32 s12, s36, s54
    s_cselect_b32 s13, s37, s55
    buffer_load_dword v16, v10, s[12:15], 0 offen
    buffer_load_dword v17, v10, s[12:15], 0 offen offset:128
    buffer_load_dword v18, v11, s[12:15], 0 offen
    s_mov_b32 s24, s62
    s_mov_b32 s25, s63
    s_mov_b32 s26, 2097152
    s_mov_b32 s27, 0x20000
    s_cbranch_scc0 L_nox
    v_lshrrev_b32 v12, 5, v0
    v_mul_u32_u24 v12, 1152, v12
    v_and_b32 v13, 31, v0
    v_lshl_add_u32 v12, v13, 2, v12
    buffer_load_dword v60, v12, s[12:15], 0 offen offset:0
    buffer_load_dword v61, v12, s[12:15], 0 offen offset:128
    buffer_load_dword v62, v12, s[12:15], 0 offen offset:256
    buffer_load_dword v63, v12, s[12:15], 0 offen offset:384
    buffer_load_dword v64, v12, s[12:15], 0 offen offset:512
    buffer_load_dword v65, v12, s[12:15], 0 offen offset:640
    buffer_load_dword v66, v12, s[12:15], 0 offen offset:768
    buffer_load_dword v67, v12, s[12:15], 0 offen offset:896
    buffer_load_dword v68, v12, s[12:15], 0 offen offset:1024
L_nox:
    s_load_dword s34, s[62:63], 786432
L_dma_job:
    s_mov_b32 m0, s29
    s_add_u32 s29, s29, 1024
    buffer_load_dwordx4 v3, s[8:11], s16 offen nt lds
    s_add_u32 s16, s16, s17
    s_mov_b32 m0, s29
    s_add_u32 s29, s29, 1024
    buffer_load_dwordx4 v4, s[8:11], s16 offen nt lds
    s_add_u32 s16, s16, s17
    s_sub_u32 s19, s19, 1
    s_cmp_lg_u32 s19, 0
    s_cbranch_scc1 L_dma_job
    s_barrier
L_job2:
    v_bfe_u32 v4, v0, 2, 2
    v_lshrrev_b32 v5, 4, v0
    v_lshl_add_u32 v4, v5, 3, v4
    v_lshlrev_b32 v4, 7, v4
    v_and_b32 v6, 3, v0
    v_lshl_add_u32 v4, v6, 3, v4
    v_bfe_u32 v7, v0, 3, 2
    v_xor_b32 v7, s3, v7
    v_lshl_add_u32 v2, v7, 5, v4
    v_and_b32 v3, 1, v0
    v_mul_u32_u24 v3, 1152, v3
    v_lshl_add_u32 v3, v5, 4, v3
    s_waitcnt vmcnt(18)
    v_and_b32 v71, 0xffff0000, v16
    v_lshlrev_b32 v70, 16, v16
    v_and_b32 v73, 0xffff0000, v17
    v_lshlrev_b32 v72, 16, v17
    v_and_b32 v75, 0xffff0000, v18
    v_lshlrev_b32 v74, 16, v18
    s_cmp_eq_u32 s21, 3
    s_cbranch_scc1 L_prep_q
    s_mov_b32 s28, 3216550459
    s_mov_b32 s29, 0xb2a57060
    s_mov_b32 s30, 0x3f317218
    v_mul_f32 v24, s28, v70
    v_mul_f32 v25, s28, v71
    v_mul_f32 v26, s28, v72
    v_mul_f32 v27, s28, v73
    v_mul_f32 v28, s28, v74
    v_mul_f32 v29, s28, v75
    v_fma_f32 v30, v70, s28, -v24
    v_fma_f32 v31, v71, s28, -v25
    v_fma_f32 v32, v72, s28, -v26
    v_fma_f32 v33, v73, s28, -v27
    v_fma_f32 v34, v74, s28, -v28
    v_fma_f32 v35, v75, s28, -v29
    v_fma_f32 v30, v70, s29, v30
    v_fma_f32 v31, v71, s29, v31
    v_fma_f32 v32, v72, s29, v32
    v_fma_f32 v33, v73, s29, v33
    v_fma_f32 v34, v74, s29, v34
    v_fma_f32 v35, v75, s29, v35
    v_min_f32 v24, 0x42fc0000, v24
    v_min_f32 v25, 0x42fc0000, v25
    v_min_f32 v26, 0x42fc0000, v26
    v_min_f32 v27, 0x42fc0000, v27
    v_min_f32 v28, 0x42fc0000, v28
    v_min_f32 v29, 0x42fc0000, v29
    v_exp_f32 v24, v24
    v_exp_f32 v25, v25
    v_exp_f32 v26, v26
    v_exp_f32 v27, v27
    v_exp_f32 v28, v28
    v_exp_f32 v29, v29
    v_mul_f32 v30, s30, v30
    v_mul_f32 v31, s30, v31
    v_mul_f32 v32, s30, v32
    v_mul_f32 v33, s30, v33
    v_mul_f32 v34, s30, v34
    v_mul_f32 v35, s30, v35
    v_fma_f32 v24, v24, v30, v24
    v_fma_f32 v25, v25, v31, v25
    v_fma_f32 v26, v26, v32, v26
    v_fma_f32 v27, v27, v33, v27
    v_fma_f32 v28, v28, v34, v28
    v_fma_f32 v29, v29, v35, v29
    v_add_f32 v24, 1.0, v24
    v_add_f32 v25, 1.0, v25
    v_add_f32 v26, 1.0, v26
    v_add_f32 v27, 1.0, v27
    v_add_f32 v28, 1.0, v28
    v_add_f32 v29, 1.0, v29
    v_rcp_f32 v30, v24
    v_rcp_f32 v31, v25
    v_rcp_f32 v32, v26
    v_rcp_f32 v33, v27
    v_rcp_f32 v34, v28
    v_rcp_f32 v35, v29
    v_mul_f32 v36, v70, v30
    v_mul_f32 v37, v71, v31
    v_mul_f32 v38, v72, v32
    v_mul_f32 v39, v73, v33
    v_mul_f32 v40, v74, v34
    v_mul_f32 v41, v75, v35
    v_fma_f32 v70, -v24, v36, v70
    v_fma_f32 v71, -v25, v37, v71
    v_fma_f32 v72, -v26, v38, v72
    v_fma_f32 v73, -v27, v39, v73
    v_fma_f32 v74, -v28, v40, v74
    v_fma_f32 v75, -v29, v41, v75
    v_fma_f32 v70, v70, v30, v36
    v_fma_f32 v71, v71, v31, v37
    v_fma_f32 v72, v72, v32, v38
    v_fma_f32 v73, v73, v33, v39
    v_fma_f32 v74, v74, v34, v40
    v_fma_f32 v75, v75, v35, v41
    v_cvt_pk_bf16_f32 v16, v70, v71
    v_cvt_pk_bf16_f32 v17, v72, v73
    v_cvt_pk_bf16_f32 v18, v74, v75
    ds_write_b32 v10, v16 offset:5888
    ds_write_b32 v10, v17 offset:6016
    ds_write_b32 v11, v18 offset:5888
    s_mov_b64 s[88:89], 0
    s_mov_b64 exec, 0
    s_branch L_mst
L_ret_m:
    s_mov_b64 s[88:89], -1
    s_mov_b64 exec, -1
    s_waitcnt vmcnt(0)
    v_mov_b32 v16, 1
    s_mov_b64 exec, 1
    ds_add_u32 v1, v16 offset:28
    s_mov_b64 exec, -1
    s_mov_b32 s7, 0
L_lw_1:
    ds_read_b32 v16, v1 offset:28
    s_waitcnt lgkmcnt(0)
    v_readfirstlane_b32 s28, v16
    s_nop 0
    s_cmp_ge_u32 s28, 4
    s_cbranch_scc1 L_lwd_2
    s_add_u32 s7, s7, 1
    s_cmp_lt_u32 s7, 1048576
    s_cbranch_scc1 L_lw_1
L_lwd_2:
L_mst:
    v_add_u32 v5, 90112, v2
    v_add_u32 v6, 126976, v2
    ds_read_b64_tr_b16 v[96:97], v5 offset:0
    ds_read_b64_tr_b16 v[98:99], v5 offset:512
    ds_read_b64_tr_b16 v[100:101], v5 offset:4096
    ds_read_b64_tr_b16 v[102:103], v5 offset:4608
    ds_read_b64_tr_b16 v[104:105], v5 offset:8192
    ds_read_b64_tr_b16 v[106:107], v5 offset:8704
    ds_read_b64_tr_b16 v[108:109], v5 offset:12288
    ds_read_b64_tr_b16 v[110:111], v5 offset:12800
    ds_read_b64_tr_b16 v[112:113], v5 offset:16384
    ds_read_b64_tr_b16 v[114:115], v5 offset:16896
    ds_read_b64_tr_b16 v[116:117], v5 offset:20480
    ds_read_b64_tr_b16 v[118:119], v5 offset:20992
    ds_read_b64_tr_b16 v[120:121], v5 offset:24576
    ds_read_b64_tr_b16 v[122:123], v5 offset:25088
    ds_read_b64_tr_b16 v[124:125], v5 offset:28672
    ds_read_b64_tr_b16 v[126:127], v5 offset:29184
    ds_read_b64_tr_b16 v[128:129], v5 offset:32768
    ds_read_b64_tr_b16 v[130:131], v5 offset:33280
    ds_read_b64_tr_b16 v[132:133], v6 offset:0
    ds_read_b64_tr_b16 v[134:135], v6 offset:512
    ds_read_b64_tr_b16 v[136:137], v6 offset:4096
    ds_read_b64_tr_b16 v[138:139], v6 offset:4608
    ds_read_b64_tr_b16 v[140:141], v6 offset:8192
    ds_read_b64_tr_b16 v[142:143], v6 offset:8704
    ds_read_b64_tr_b16 v[144:145], v6 offset:12288
    ds_read_b64_tr_b16 v[146:147], v6 offset:12800
    ds_read_b64_tr_b16 v[148:149], v6 offset:16384
    ds_read_b64_tr_b16 v[150:151], v6 offset:16896
    ds_read_b64_tr_b16 v[152:153], v6 offset:20480
    ds_read_b64_tr_b16 v[154:155], v6 offset:20992
    ds_read_b64_tr_b16 v[156:157], v6 offset:24576
    ds_read_b64_tr_b16 v[158:159], v6 offset:25088
    ds_read_b64_tr_b16 v[160:161], v6 offset:28672
    ds_read_b64_tr_b16 v[162:163], v6 offset:29184
    ds_read_b64_tr_b16 v[164:165], v6 offset:32768
    ds_read_b64_tr_b16 v[166:167], v6 offset:33280
    s_branch L_gemv
L_prep_q:
    v_lshlrev_b32 v24, 16, v60
    v_and_b32 v25, 0xffff0000, v60
    v_lshlrev_b32 v26, 16, v61
    v_and_b32 v27, 0xffff0000, v61
    v_lshlrev_b32 v28, 16, v62
    v_and_b32 v29, 0xffff0000, v62
    v_lshlrev_b32 v30, 16, v63
    v_and_b32 v31, 0xffff0000, v63
    v_lshlrev_b32 v32, 16, v64
    v_and_b32 v33, 0xffff0000, v64
    v_lshlrev_b32 v34, 16, v65
    v_and_b32 v35, 0xffff0000, v65
    v_lshlrev_b32 v36, 16, v66
    v_and_b32 v37, 0xffff0000, v66
    v_lshlrev_b32 v38, 16, v67
    v_and_b32 v39, 0xffff0000, v67
    v_lshlrev_b32 v40, 16, v68
    v_and_b32 v41, 0xffff0000, v68
    v_add_f32 v16, v24, v25
    v_add_f32 v16, v16, v26
    v_add_f32 v16, v16, v27
    v_add_f32 v16, v16, v28
    v_add_f32 v16, v16, v29
    v_add_f32 v16, v16, v30
    v_add_f32 v16, v16, v31
    v_add_f32 v16, v16, v32
    v_add_f32 v16, v16, v33
    v_add_f32 v16, v16, v34
    v_add_f32 v16, v16, v35
    v_add_f32 v16, v16, v36
    v_add_f32 v16, v16, v37
    v_add_f32 v16, v16, v38
    v_add_f32 v16, v16, v39
    v_add_f32 v16, v16, v40
    v_add_f32 v16, v16, v41
    s_nop 1
    v_add_f32_dpp v16, v16, v16 row_ror:1 row_mask:0xf bank_mask:0xf
    s_nop 1
    v_add_f32_dpp v16, v16, v16 row_ror:2 row_mask:0xf bank_mask:0xf
    s_nop 1
    v_add_f32_dpp v16, v16, v16 row_ror:4 row_mask:0xf bank_mask:0xf
    s_nop 1
    v_add_f32_dpp v16, v16, v16 row_ror:8 row_mask:0xf bank_mask:0xf
    v_mov_b32 v17, v16
    s_nop 1
    v_permlane16_swap_b32 v16, v17
    v_add_f32 v16, v16, v17
    s_mov_b32 s28, 0x3ae38e39
    s_mov_b32 s29, 0x3727c5ac
    v_mul_f32 v16, s28, v16
    v_mov_b32 v18, 0
    v_sub_f32 v17, v24, v16
    v_fmac_f32 v18, v17, v17
    v_sub_f32 v17, v25, v16
    v_fmac_f32 v18, v17, v17
    v_sub_f32 v17, v26, v16
    v_fmac_f32 v18, v17, v17
    v_sub_f32 v17, v27, v16
    v_fmac_f32 v18, v17, v17
    v_sub_f32 v17, v28, v16
    v_fmac_f32 v18, v17, v17
    v_sub_f32 v17, v29, v16
    v_fmac_f32 v18, v17, v17
    v_sub_f32 v17, v30, v16
    v_fmac_f32 v18, v17, v17
    v_sub_f32 v17, v31, v16
    v_fmac_f32 v18, v17, v17
    v_sub_f32 v17, v32, v16
    v_fmac_f32 v18, v17, v17
    v_sub_f32 v17, v33, v16
    v_fmac_f32 v18, v17, v17
    v_sub_f32 v17, v34, v16
    v_fmac_f32 v18, v17, v17
    v_sub_f32 v17, v35, v16
    v_fmac_f32 v18, v17, v17
    v_sub_f32 v17, v36, v16
    v_fmac_f32 v18, v17, v17
    v_sub_f32 v17, v37, v16
    v_fmac_f32 v18, v17, v17
    v_sub_f32 v17, v38, v16
    v_fmac_f32 v18, v17, v17
    v_sub_f32 v17, v39, v16
    v_fmac_f32 v18, v17, v17
    v_sub_f32 v17, v40, v16
    v_fmac_f32 v18, v17, v17
    v_sub_f32 v17, v41, v16
    v_fmac_f32 v18, v17, v17
    s_nop 1
    v_add_f32_dpp v18, v18, v18 row_ror:1 row_mask:0xf bank_mask:0xf
    s_nop 1
    v_add_f32_dpp v18, v18, v18 row_ror:2 row_mask:0xf bank_mask:0xf
    s_nop 1
    v_add_f32_dpp v18, v18, v18 row_ror:4 row_mask:0xf bank_mask:0xf
    s_nop 1
    v_add_f32_dpp v18, v18, v18 row_ror:8 row_mask:0xf bank_mask:0xf
    v_mov_b32 v17, v18
    s_nop 1
    v_permlane16_swap_b32 v18, v17
    v_add_f32 v18, v18, v17
    v_mul_f32 v18, s28, v18
    v_cvt_pk_bf16_f32 v18, v18, v18
    v_and_b32 v18, 0xffff0000, v18
    v_add_f32 v18, s29, v18
    v_cvt_pk_bf16_f32 v18, v18, v18
    v_and_b32 v18, 0xffff0000, v18
    v_sqrt_f32 v18, v18
    s_nop 0
    v_cvt_pk_bf16_f32 v18, v18, v18
    v_and_b32 v18, 0xffff0000, v18
    v_rcp_f32 v19, v18
    v_cvt_pk_bf16_f32 v16, v16, v16
    v_and_b32 v16, 0xffff0000, v16
    v_sub_f32 v70, v70, v16
    v_cvt_pk_bf16_f32 v70, v70, v70
    v_and_b32 v70, 0xffff0000, v70
    v_mul_f32 v17, v70, v19
    v_fma_f32 v70, -v18, v17, v70
    v_fma_f32 v70, v70, v19, v17
    v_cvt_pk_bf16_f32 v70, v70, v70
    v_and_b32 v70, 0xffff0000, v70
    v_sub_f32 v71, v71, v16
    v_cvt_pk_bf16_f32 v71, v71, v71
    v_and_b32 v71, 0xffff0000, v71
    v_mul_f32 v17, v71, v19
    v_fma_f32 v71, -v18, v17, v71
    v_fma_f32 v71, v71, v19, v17
    v_cvt_pk_bf16_f32 v71, v71, v71
    v_and_b32 v71, 0xffff0000, v71
    v_sub_f32 v72, v72, v16
    v_cvt_pk_bf16_f32 v72, v72, v72
    v_and_b32 v72, 0xffff0000, v72
    v_mul_f32 v17, v72, v19
    v_fma_f32 v72, -v18, v17, v72
    v_fma_f32 v72, v72, v19, v17
    v_cvt_pk_bf16_f32 v72, v72, v72
    v_and_b32 v72, 0xffff0000, v72
    v_sub_f32 v73, v73, v16
    v_cvt_pk_bf16_f32 v73, v73, v73
    v_and_b32 v73, 0xffff0000, v73
    v_mul_f32 v17, v73, v19
    v_fma_f32 v73, -v18, v17, v73
    v_fma_f32 v73, v73, v19, v17
    v_cvt_pk_bf16_f32 v73, v73, v73
    v_and_b32 v73, 0xffff0000, v73
    v_sub_f32 v74, v74, v16
    v_cvt_pk_bf16_f32 v74, v74, v74
    v_and_b32 v74, 0xffff0000, v74
    v_mul_f32 v17, v74, v19
    v_fma_f32 v74, -v18, v17, v74
    v_fma_f32 v74, v74, v19, v17
    v_cvt_pk_bf16_f32 v74, v74, v74
    v_and_b32 v74, 0xffff0000, v74
    v_sub_f32 v75, v75, v16
    v_cvt_pk_bf16_f32 v75, v75, v75
    v_and_b32 v75, 0xffff0000, v75
    v_mul_f32 v17, v75, v19
    v_fma_f32 v75, -v18, v17, v75
    v_fma_f32 v75, v75, v19, v17
    v_cvt_pk_bf16_f32 v75, v75, v75
    v_and_b32 v75, 0xffff0000, v75
    s_waitcnt vmcnt(0)
    v_mov_b32 v16, 1
    s_mov_b64 exec, 1
    ds_add_u32 v1, v16 offset:28
    s_mov_b64 exec, -1
    s_mov_b32 s7, 0
L_lw_3:
    ds_read_b32 v16, v1 offset:28
    s_waitcnt lgkmcnt(0)
    v_readfirstlane_b32 s28, v16
    s_nop 0
    s_cmp_ge_u32 s28, 4
    s_cbranch_scc1 L_lwd_4
    s_add_u32 s7, s7, 1
    s_cmp_lt_u32 s7, 1048576
    s_cbranch_scc1 L_lw_3
L_lwd_4:
    v_add_u32 v5, 90112, v2
    v_add_u32 v6, 126976, v2
    ds_read_b64_tr_b16 v[96:97], v5 offset:0
    ds_read_b64_tr_b16 v[98:99], v5 offset:512
    ds_read_b64_tr_b16 v[100:101], v5 offset:4096
    ds_read_b64_tr_b16 v[102:103], v5 offset:4608
    ds_read_b64_tr_b16 v[104:105], v5 offset:8192
    ds_read_b64_tr_b16 v[106:107], v5 offset:8704
    ds_read_b64_tr_b16 v[108:109], v5 offset:12288
    ds_read_b64_tr_b16 v[110:111], v5 offset:12800
    ds_read_b64_tr_b16 v[112:113], v5 offset:16384
    ds_read_b64_tr_b16 v[114:115], v5 offset:16896
    ds_read_b64_tr_b16 v[116:117], v5 offset:20480
    ds_read_b64_tr_b16 v[118:119], v5 offset:20992
    ds_read_b64_tr_b16 v[120:121], v5 offset:24576
    ds_read_b64_tr_b16 v[122:123], v5 offset:25088
    ds_read_b64_tr_b16 v[124:125], v5 offset:28672
    ds_read_b64_tr_b16 v[126:127], v5 offset:29184
    ds_read_b64_tr_b16 v[128:129], v5 offset:32768
    ds_read_b64_tr_b16 v[130:131], v5 offset:33280
    ds_read_b64_tr_b16 v[132:133], v6 offset:0
    ds_read_b64_tr_b16 v[134:135], v6 offset:512
    ds_read_b64_tr_b16 v[136:137], v6 offset:4096
    ds_read_b64_tr_b16 v[138:139], v6 offset:4608
    ds_read_b64_tr_b16 v[140:141], v6 offset:8192
    ds_read_b64_tr_b16 v[142:143], v6 offset:8704
    ds_read_b64_tr_b16 v[144:145], v6 offset:12288
    ds_read_b64_tr_b16 v[146:147], v6 offset:12800
    ds_read_b64_tr_b16 v[148:149], v6 offset:16384
    ds_read_b64_tr_b16 v[150:151], v6 offset:16896
    ds_read_b64_tr_b16 v[152:153], v6 offset:20480
    ds_read_b64_tr_b16 v[154:155], v6 offset:20992
    ds_read_b64_tr_b16 v[156:157], v6 offset:24576
    ds_read_b64_tr_b16 v[158:159], v6 offset:25088
    ds_read_b64_tr_b16 v[160:161], v6 offset:28672
    ds_read_b64_tr_b16 v[162:163], v6 offset:29184
    ds_read_b64_tr_b16 v[164:165], v6 offset:32768
    ds_read_b64_tr_b16 v[166:167], v6 offset:33280
    s_waitcnt lgkmcnt(0)
    s_waitcnt lgkmcnt(0)
    s_mul_i32 s35, s34, 0x9E3779B1
    s_add_u32 s35, s35, 0x7F4A7C15
    s_mov_b32 s90, 0xfffff000
    s_mov_b64 s[88:89], 0
    s_mov_b64 exec, 0
    s_branch L_qh
L_ret_q:
    s_mov_b64 s[88:89], -1
    s_mov_b64 exec, -1
    s_cmp_eq_u32 s5, 22
    s_cbranch_scc1 L_kms
    s_cmp_eq_u32 s2, 215
    s_cbranch_scc1 L_kms
    s_mov_b32 s7, 0
L_lw_5:
    ds_read_b32 v16, v1 offset:60
    s_waitcnt lgkmcnt(0)
    v_readfirstlane_b32 s28, v16
    s_nop 0
    s_cmp_ge_u32 s28, 1
    s_cbranch_scc1 L_lwd_6
    s_sleep 4
    s_add_u32 s7, s7, 1
    s_cmp_lt_u32 s7, 1048576
    s_cbranch_scc1 L_lw_5
L_lwd_6:
L_kms:
    s_mov_b32 s30, 851968
    s_mov_b32 s31, 856576
    v_lshlrev_b32 v12, 4, v8
    v_lshlrev_b32 v13, 4, v9
    s_mov_b32 s7, 0
L_pl_7:
    buffer_load_dwordx4 v[36:39], v12, s[24:27], s30 offen sc1
    buffer_load_dwordx4 v[40:43], v12, s[24:27], s30 offen offset:512 sc1
    buffer_load_dwordx4 v[44:47], v13, s[24:27], s30 offen sc1
    buffer_load_dwordx4 v[48:51], v12, s[24:27], s31 offen sc1
    buffer_load_dwordx4 v[52:55], v12, s[24:27], s31 offen offset:512 sc1
    buffer_load_dwordx4 v[56:59], v13, s[24:27], s31 offen sc1
    s_waitcnt vmcnt(0)
    v_xor_b32 v14, s35, v37
    v_bitop3_b32 v14, v14, v39, s35 bitop3:0xf6
    v_bitop3_b32 v14, v14, v41, s35 bitop3:0xf6
    v_bitop3_b32 v14, v14, v43, s35 bitop3:0xf6
    v_bitop3_b32 v14, v14, v45, s35 bitop3:0xf6
    v_bitop3_b32 v14, v14, v47, s35 bitop3:0xf6
    v_bitop3_b32 v14, v14, v49, s35 bitop3:0xf6
    v_bitop3_b32 v14, v14, v51, s35 bitop3:0xf6
    v_bitop3_b32 v14, v14, v53, s35 bitop3:0xf6
    v_bitop3_b32 v14, v14, v55, s35 bitop3:0xf6
    v_bitop3_b32 v14, v14, v57, s35 bitop3:0xf6
    v_bitop3_b32 v14, v14, v59, s35 bitop3:0xf6
    v_cmp_ne_u32 vcc, 0, v14
    s_nop 0
    s_cbranch_vccz L_pld_8
    s_sleep 2
    s_add_u32 s7, s7, 1
    s_cmp_lt_u32 s7, 131072
    s_cbranch_scc1 L_pl_7
L_pld_8:
L_qh:
    v_cmp_gt_u32 vcc, 32, v0
    v_mov_b32 v12, 0x03020c0c
    v_mov_b32 v13, 0x01000c0c
    v_cndmask_b32 v12, v12, v13, vcc
    v_perm_b32 v24, v36, v36, v12
    v_perm_b32 v25, v38, v38, v12
    v_perm_b32 v26, v40, v40, v12
    v_perm_b32 v27, v42, v42, v12
    v_perm_b32 v28, v44, v44, v12
    v_perm_b32 v29, v46, v46, v12
    v_perm_b32 v30, v48, v48, v12
    v_perm_b32 v31, v50, v50, v12
    v_perm_b32 v32, v52, v52, v12
    v_perm_b32 v33, v54, v54, v12
    v_perm_b32 v34, v56, v56, v12
    v_perm_b32 v35, v58, v58, v12
    v_add_f32 v30, 1.0, v30
    v_cvt_pk_bf16_f32 v30, v30, v30
    v_and_b32 v30, 0xffff0000, v30
    v_mul_f32 v70, v70, v30
    v_cvt_pk_bf16_f32 v70, v70, v70
    v_and_b32 v70, 0xffff0000, v70
    v_add_f32 v70, v70, v24
    v_add_f32 v31, 1.0, v31
    v_cvt_pk_bf16_f32 v31, v31, v31
    v_and_b32 v31, 0xffff0000, v31
    v_mul_f32 v71, v71, v31
    v_cvt_pk_bf16_f32 v71, v71, v71
    v_and_b32 v71, 0xffff0000, v71
    v_add_f32 v71, v71, v25
    v_add_f32 v32, 1.0, v32
    v_cvt_pk_bf16_f32 v32, v32, v32
    v_and_b32 v32, 0xffff0000, v32
    v_mul_f32 v72, v72, v32
    v_cvt_pk_bf16_f32 v72, v72, v72
    v_and_b32 v72, 0xffff0000, v72
    v_add_f32 v72, v72, v26
    v_add_f32 v33, 1.0, v33
    v_cvt_pk_bf16_f32 v33, v33, v33
    v_and_b32 v33, 0xffff0000, v33
    v_mul_f32 v73, v73, v33
    v_cvt_pk_bf16_f32 v73, v73, v73
    v_and_b32 v73, 0xffff0000, v73
    v_add_f32 v73, v73, v27
    v_add_f32 v34, 1.0, v34
    v_cvt_pk_bf16_f32 v34, v34, v34
    v_and_b32 v34, 0xffff0000, v34
    v_mul_f32 v74, v74, v34
    v_cvt_pk_bf16_f32 v74, v74, v74
    v_and_b32 v74, 0xffff0000, v74
    v_add_f32 v74, v74, v28
    v_add_f32 v35, 1.0, v35
    v_cvt_pk_bf16_f32 v35, v35, v35
    v_and_b32 v35, 0xffff0000, v35
    v_mul_f32 v75, v75, v35
    v_cvt_pk_bf16_f32 v75, v75, v75
    v_and_b32 v75, 0xffff0000, v75
    v_add_f32 v75, v75, v29
    v_cvt_pk_bf16_f32 v16, v70, v71
    v_cvt_pk_bf16_f32 v17, v72, v73
    v_cvt_pk_bf16_f32 v18, v74, v75
    ds_write_b32 v10, v16 offset:5888
    ds_write_b32 v10, v17 offset:6016
    ds_write_b32 v11, v18 offset:5888
    s_cbranch_execz L_gemv
    v_mov_b32 v16, 1
    s_mov_b64 exec, 1
    ds_add_u32 v1, v16 offset:32
    s_mov_b64 exec, -1
    s_mov_b32 s7, 0
L_lw_9:
    ds_read_b32 v16, v1 offset:32
    s_waitcnt lgkmcnt(0)
    v_readfirstlane_b32 s28, v16
    s_nop 0
    s_cmp_ge_u32 s28, 4
    s_cbranch_scc1 L_lwd_10
    s_add_u32 s7, s7, 1
    s_cmp_lt_u32 s7, 1048576
    s_cbranch_scc1 L_lw_9
L_lwd_10:
L_gemv:
    ds_read_b128 v[24:27], v3 offset:5888
    ds_read_b128 v[28:31], v3 offset:5952
    ds_read_b128 v[32:35], v3 offset:6016
    ds_read_b128 v[36:39], v3 offset:6080
    ds_read_b128 v[40:43], v3 offset:6144
    ds_read_b128 v[44:47], v3 offset:6208
    s_waitcnt lgkmcnt(5)
    v_mfma_f32_16x16x32_bf16 v[20:23], v[24:27], v[96:99], 0
    ds_read_b128 v[48:51], v3 offset:6272
    s_waitcnt lgkmcnt(5)
    v_mfma_f32_16x16x32_bf16 v[20:23], v[28:31], v[100:103], v[20:23]
    ds_read_b128 v[52:55], v3 offset:6336
    s_waitcnt lgkmcnt(5)
    v_mfma_f32_16x16x32_bf16 v[20:23], v[32:35], v[104:107], v[20:23]
    ds_read_b128 v[56:59], v3 offset:6400
    s_waitcnt lgkmcnt(5)
    v_mfma_f32_16x16x32_bf16 v[20:23], v[36:39], v[108:111], v[20:23]
    ds_read_b128 v[60:63], v3 offset:6464
    s_waitcnt lgkmcnt(5)
    v_mfma_f32_16x16x32_bf16 v[20:23], v[40:43], v[112:115], v[20:23]
    ds_read_b128 v[64:67], v3 offset:6528
    s_waitcnt lgkmcnt(5)
    v_mfma_f32_16x16x32_bf16 v[20:23], v[44:47], v[116:119], v[20:23]
    ds_read_b128 v[68:71], v3 offset:6592
    s_waitcnt lgkmcnt(5)
    v_mfma_f32_16x16x32_bf16 v[20:23], v[48:51], v[120:123], v[20:23]
    ds_read_b128 v[72:75], v3 offset:6656
    s_waitcnt lgkmcnt(5)
    v_mfma_f32_16x16x32_bf16 v[20:23], v[52:55], v[124:127], v[20:23]
    ds_read_b128 v[76:79], v3 offset:6720
    s_waitcnt lgkmcnt(5)
    v_mfma_f32_16x16x32_bf16 v[20:23], v[56:59], v[128:131], v[20:23]
    ds_read_b128 v[80:83], v3 offset:6784
    s_waitcnt lgkmcnt(5)
    v_mfma_f32_16x16x32_bf16 v[20:23], v[60:63], v[132:135], v[20:23]
    ds_read_b128 v[84:87], v3 offset:6848
    s_waitcnt lgkmcnt(5)
    v_mfma_f32_16x16x32_bf16 v[20:23], v[64:67], v[136:139], v[20:23]
    ds_read_b128 v[88:91], v3 offset:6912
    s_waitcnt lgkmcnt(5)
    v_mfma_f32_16x16x32_bf16 v[20:23], v[68:71], v[140:143], v[20:23]
    ds_read_b128 v[92:95], v3 offset:6976
    s_waitcnt lgkmcnt(5)
    v_mfma_f32_16x16x32_bf16 v[20:23], v[72:75], v[144:147], v[20:23]
    s_waitcnt lgkmcnt(4)
    v_mfma_f32_16x16x32_bf16 v[20:23], v[76:79], v[148:151], v[20:23]
    s_waitcnt lgkmcnt(3)
    v_mfma_f32_16x16x32_bf16 v[20:23], v[80:83], v[152:155], v[20:23]
    s_waitcnt lgkmcnt(2)
    v_mfma_f32_16x16x32_bf16 v[20:23], v[84:87], v[156:159], v[20:23]
    s_waitcnt lgkmcnt(1)
    v_mfma_f32_16x16x32_bf16 v[20:23], v[88:91], v[160:163], v[20:23]
    s_waitcnt lgkmcnt(0)
    v_mfma_f32_16x16x32_bf16 v[20:23], v[92:95], v[164:167], v[20:23]
    s_waitcnt lgkmcnt(0)
    s_mul_i32 s35, s34, 0x9E3779B1
    s_add_u32 s35, s35, 0x7F4A7C15
    s_mov_b32 s90, 0xfffff000
    s_lshl_b32 s28, s22, 2
    s_add_u32 s28, s28, s3
    s_lshl_b32 s28, s28, 7
    s_mov_b32 s29, 851968
    s_cmp_eq_u32 s21, 3
    s_cselect_b32 s29, 819200, s29
    s_add_u32 s28, s28, s29
    v_lshlrev_b32 v2, 3, v0
    v_cvt_pk_bf16_f32 v8, v20, v21
    v_mov_b32 v9, s35
    s_cbranch_execnz L_jpub
    s_cmp_eq_u32 s21, 3
    s_cbranch_scc1 L_ret_q
    s_branch L_ret_m
L_jpub:
    s_mov_b64 exec, 0xffff
    buffer_store_dwordx2 v[8:9], v2, s[24:27], s28 offen sc1
    s_mov_b64 exec, -1
    v_mov_b32 v16, 1
    s_mov_b64 exec, 1
    ds_add_u32 v1, v16 offset:24
    s_mov_b64 exec, -1
L_roles:
    s_cmp_eq_u32 s3, 3
    s_cbranch_scc1 L_s3
    s_cmp_eq_u32 s3, 0
    s_cbranch_scc1 L_s0
    s_branch L_tailprep
L_s0:
    s_waitcnt lgkmcnt(0)
    s_mul_i32 s35, s34, 0x9E3779B1
    s_add_u32 s35, s35, 0x7F4A7C15
    s_mov_b32 s90, 0xfffff000
    v_lshlrev_b32 v2, 4, v0
    s_mov_b32 s7, 0
L_lw_11:
    ds_read_b32 v8, v1 offset:36
    s_waitcnt lgkmcnt(0)
    v_readfirstlane_b32 s28, v8
    s_nop 0
    s_cmp_ge_u32 s28, 1
    s_cbranch_scc1 L_lwd_12
    s_sleep 8
    s_add_u32 s7, s7, 1
    s_cmp_lt_u32 s7, 1048576
    s_cbranch_scc1 L_lw_11
L_lwd_12:
L_qgo:
    s_lshl_b32 s28, s4, 12
    s_bfe_u32 s29, s5, 0x10003
    s_lshl_b32 s29, s29, 11
    s_add_u32 s28, s28, s29
    s_add_u32 s28, s28, 819200
    s_mov_b32 s7, 0
L_pl_13:
    buffer_load_dwordx4 v[8:11], v2, s[24:27], s28 offen sc1
    buffer_load_dwordx4 v[12:15], v2, s[24:27], s28 offen offset:1024 sc1
    s_waitcnt vmcnt(0)
    v_xor_b32 v16, s35, v9
    v_bitop3_b32 v16, v16, v11, s35 bitop3:0xf6
    v_bitop3_b32 v16, v16, v13, s35 bitop3:0xf6
    v_bitop3_b32 v16, v16, v15, s35 bitop3:0xf6
    v_cmp_ne_u32 vcc, 0, v16
    s_nop 0
    s_cbranch_vccz L_pld_14
    s_sleep 16
    s_add_u32 s7, s7, 1
    s_cmp_lt_u32 s7, 131072
    s_cbranch_scc1 L_pl_13
L_pld_14:
    s_mov_b32 s29, 0x05040100
    s_cmp_ge_u32 s5, 16
    s_cselect_b32 s29, 0x07060302, s29
    v_perm_b32 v8, v10, v8, s29
    v_perm_b32 v9, v14, v12, s29
    v_lshlrev_b32 v3, 2, v0
    ds_write_b32 v3, v8 offset:256
    ds_write_b32 v3, v9 offset:512
    s_add_u32 s7, s7, 1
    v_mov_b32 v10, s7
    ds_write_b32 v1, v10 offset:4
    s_mov_b32 s7, 0
L_lw_15:
    ds_read_b32 v8, v1 offset:0
    s_waitcnt lgkmcnt(0)
    v_readfirstlane_b32 s28, v8
    s_nop 0
    s_cmp_ge_u32 s28, 1
    s_cbranch_scc1 L_lwd_16
    s_sleep 4
    s_add_u32 s7, s7, 1
    s_cmp_lt_u32 s7, 1048576
    s_cbranch_scc1 L_lw_15
L_lwd_16:
    s_mov_b32 s6, s28
    s_mov_b32 s7, 0
L_lw_17:
    ds_read_b32 v8, v1 offset:8
    s_waitcnt lgkmcnt(0)
    v_readfirstlane_b32 s28, v8
    s_nop 0
    s_cmp_ge_u32 s28, 8
    s_cbranch_scc1 L_lwd_18
    s_sleep 4
    s_add_u32 s7, s7, 1
    s_cmp_lt_u32 s7, 1048576
    s_cbranch_scc1 L_lw_17
L_lwd_18:
    v_and_b32 v3, 15, v0
    v_lshlrev_b32 v4, 3, v3
    ds_read_b64 v[8:9], v4 offset:128
    s_mov_b32 s31, 1069066811
    s_waitcnt lgkmcnt(0)
    v_mov_b32 v10, v8
    s_nop 1
    v_max_f32_dpp v10, v10, v10 row_ror:2 row_mask:0xf bank_mask:0xf
    s_nop 1
    v_max_f32_dpp v10, v10, v10 row_ror:4 row_mask:0xf bank_mask:0xf
    s_nop 1
    v_max_f32_dpp v10, v10, v10 row_ror:8 row_mask:0xf bank_mask:0xf
    v_sub_f32 v12, v8, v10
    v_mul_f32 v12, s31, v12
    v_exp_f32 v12, v12
    s_nop 0
    v_mul_f32 v11, v12, v9
    s_nop 1
    v_add_f32_dpp v11, v11, v11 row_ror:2 row_mask:0xf bank_mask:0xf
    s_nop 1
    v_add_f32_dpp v11, v11, v11 row_ror:4 row_mask:0xf bank_mask:0xf
    s_nop 1
    v_add_f32_dpp v11, v11, v11 row_ror:8 row_mask:0xf bank_mask:0xf
    v_and_b32 v5, 1, v0
    v_lshlrev_b32 v5, 5, v5
    v_lshrrev_b32 v6, 1, v3
    v_lshl_add_u32 v5, v6, 2, v5
    ds_write_b32 v5, v12 offset:64
    s_lshl_b32 s28, s4, 5
    s_add_u32 s28, s28, s5
    s_lshl_b32 s28, s28, 5
    s_add_u32 s28, s28, 442368
    v_mov_b32 v12, s35
    v_mov_b32 v13, s35
    v_lshlrev_b32 v4, 4, v0
    v_mov_b32 v6, s6
    ds_write_b32 v1, v6 offset:48
    s_mov_b64 exec, 3
    s_cmp_eq_u32 s6, 3
    s_cbranch_scc0 L_is_19
    buffer_store_dwordx4 v[10:13], v4, s[24:27], s28 offen
L_isd_20:
    s_mov_b64 exec, -1
    s_waitcnt lgkmcnt(0)
    s_branch L_tailprep
L_s3:
    v_lshlrev_b32 v2, 4, v0
    v_mov_b32 v4, -1
    v_mov_b32 v5, -1
    v_mov_b32 v6, -1
    v_mov_b32 v7, -1
    s_cmp_ge_u32 s5, 9
    s_cbranch_scc1 L_noclr
    s_mul_i32 s28, s4, 3072
    s_mul_i32 s29, s5, 320
    s_add_u32 s28, s28, s29
    s_add_u32 s28, s28, 409600
    s_mov_b64 exec, 0xfffff
    buffer_store_dwordx4 v[4:7], v2, s[24:27], s28 offen sc1
    s_mov_b64 exec, -1
L_noclr:
    s_getreg_b32 s29, hwreg(HW_REG_XCC_ID)
    s_and_b32 s29, s29, 15
    s_waitcnt lgkmcnt(0)
    s_mul_i32 s35, s34, 0x9E3779B1
    s_add_u32 s35, s35, 0x7F4A7C15
    s_mov_b32 s90, 0xfffff000
    v_mov_b32 v8, s29
    v_mov_b32 v9, s35
    s_lshl_b32 s28, s4, 5
    s_add_u32 s28, s28, s5
    s_lshl_b32 s28, s28, 3
    s_add_u32 s28, s28, 790528
    s_waitcnt vmcnt(0)
    s_mov_b64 exec, 1
    buffer_store_dwordx2 v[8:9], v1, s[24:27], s28 offen sc1
    s_mov_b64 exec, -1
    s_mov_b32 s7, 0
L_lw_21:
    ds_read_b32 v8, v1 offset:4
    s_waitcnt lgkmcnt(0)
    v_readfirstlane_b32 s28, v8
    s_nop 0
    s_cmp_ge_u32 s28, 1
    s_cbranch_scc1 L_lwd_22
    s_sleep 8
    s_add_u32 s7, s7, 1
    s_cmp_lt_u32 s7, 1048576
    s_cbranch_scc1 L_lw_21
L_lwd_22:
    s_mov_b32 s30, 790528
    s_mov_b32 s7, 0
L_pl_23:
    buffer_load_dwordx4 v[8:11], v2, s[24:27], s30 offen sc1
    buffer_load_dwordx4 v[12:15], v2, s[24:27], s30 offen offset:1024 sc1
    s_waitcnt vmcnt(0)
    v_xor_b32 v16, s35, v9
    v_bitop3_b32 v16, v16, v11, s35 bitop3:0xf6
    v_bitop3_b32 v16, v16, v13, s35 bitop3:0xf6
    v_bitop3_b32 v16, v16, v15, s35 bitop3:0xf6
    v_cmp_ne_u32 vcc, 0, v16
    s_nop 0
    s_cbranch_vccz L_pld_24
    s_sleep 4
    s_add_u32 s7, s7, 1
    s_cmp_lt_u32 s7, 131072
    s_cbranch_scc1 L_pl_23
L_pld_24:
    s_cmp_ge_u32 s4, 4
    s_cselect_b64 vcc, -1, 0
    v_cndmask_b32 v8, v8, v12, vcc
    v_cndmask_b32 v10, v10, v14, vcc
    v_xor_b32 v8, s29, v8
    v_bitop3_b32 v8, v8, v10, s29 bitop3:0xf6
    v_and_b32 v8, 15, v8
    v_cmp_ne_u32 vcc, 0, v8
    s_and_b32 s30, s4, 3
    s_lshl_b32 s30, s30, 4
    s_lshr_b64 s[30:31], vcc, s30
    s_and_b32 s30, s30, 0xffff
    s_cselect_b32 s6, 1, 3
    v_mov_b32 v8, s6
    ds_write_b32 v1, v8 offset:0
    s_branch L_tailprep
L_stream:
    s_mov_b32 s23, 6
    s_bitcmp1_b32 s4, 0
    s_cselect_b32 s28, 22, 12
    s_cmp_ge_u32 s5, 9
    s_cselect_b32 s23, s28, s23
    s_cmp_ge_u32 s5, 15
    s_cselect_b32 s23, 14, s23
    s_cmp_ge_u32 s5, 19
    s_cselect_b32 s23, 18, s23
    s_cmp_ge_u32 s5, 27
    s_cselect_b32 s23, 0, s23
    s_sub_u32 s29, s2, 216
    s_cmp_lt_u32 s29, 22
    s_cselect_b32 s23, s28, s23
    s_cmp_eq_u32 s5, 22
    s_cselect_b32 s23, 60, s23
    s_cmp_eq_u32 s2, 215
    s_cselect_b32 s23, 42, s23
    s_cmp_eq_u32 s2, 203
    s_cselect_b32 s23, 42, s23
    s_cmp_eq_u32 s2, 211
    s_cselect_b32 s23, 42, s23
    s_sub_u32 s29, s5, 9
    s_cmp_lt_u32 s29, 2
    s_cselect_b32 s23, 0, s23
    s_cselect_b32 s20, 6, 0
    s_cmp_ge_u32 s2, 238
    s_cselect_b32 s20, 13, s20
    s_mov_b32 s12, s40
    s_mov_b32 s13, s41
    s_mov_b32 s14, 67108864
    s_mov_b32 s15, 0x20000
    s_mov_b32 s24, s62
    s_mov_b32 s25, s63
    s_mov_b32 s26, 2097152
    s_mov_b32 s27, 0x20000
    s_load_dword s34, s[62:63], 786432
    v_and_b32 v1, 15, v0
    v_lshlrev_b32 v1, 4, v1
    v_bfe_u32 v5, v0, 4, 2
    v_mul_u32_u24 v5, 256, v5
    v_xor_b32 v1, v1, v5
    v_xor_b32 v1, s32, v1
    v_bfe_u32 v4, v0, 3, 1
    v_lshlrev_b32 v4, 8, v4
    v_lshl_add_u32 v36, v3, 4, v4
    s_barrier
    s_cmp_gt_u32 s23, 0
    s_waitcnt vmcnt(3)
    s_cbranch_scc1 L_th_25
    s_waitcnt vmcnt(2)
L_th_25:
    s_cmp_le_u32 s20, 0
    s_cbranch_scc1 L_th_26
    s_waitcnt vmcnt(1)
L_th_26:
    buffer_load_dwordx4 v[56:59], v2, s[8:11], s33 offen nt
    v_xor_b32 v2, 67584, v2
    s_cmp_gt_u32 s23, 1
    s_waitcnt vmcnt(3)
    s_cbranch_scc1 L_th_27
    s_waitcnt vmcnt(2)
L_th_27:
    s_cmp_le_u32 s20, 1
    s_cbranch_scc1 L_th_28
    s_waitcnt vmcnt(1)
L_th_28:
    buffer_load_dwordx4 v[60:63], v2, s[8:11], s33 offen nt
    v_xor_b32 v2, 99328, v2
    s_cmp_gt_u32 s23, 2
    s_waitcnt vmcnt(3)
    s_cbranch_scc1 L_th_29
    s_waitcnt vmcnt(2)
L_th_29:
    s_cmp_le_u32 s20, 2
    s_cbranch_scc1 L_th_30
    s_waitcnt vmcnt(1)
L_th_30:
    buffer_load_dwordx4 v[64:67], v2, s[8:11], s33 offen nt
    v_xor_b32 v2, 67584, v2
    s_cmp_gt_u32 s23, 3
    s_waitcnt vmcnt(3)
    s_cbranch_scc1 L_th_31
    s_waitcnt vmcnt(2)
L_th_31:
    s_cmp_le_u32 s20, 3
    s_cbranch_scc1 L_th_32
    s_waitcnt vmcnt(1)
L_th_32:
    buffer_load_dwordx4 v[68:71], v2, s[8:11], s33 offen nt
    v_xor_b32 v2, 33792, v2
    s_cmp_gt_u32 s23, 4
    s_waitcnt vmcnt(3)
    s_cbranch_scc1 L_th_33
    s_waitcnt vmcnt(2)
L_th_33:
    s_cmp_le_u32 s20, 4
    s_cbranch_scc1 L_th_34
    s_waitcnt vmcnt(1)
L_th_34:
    buffer_load_dwordx4 v[72:75], v2, s[8:11], s33 offen nt
    v_xor_b32 v2, 67584, v2
    s_cmp_gt_u32 s23, 5
    s_waitcnt vmcnt(3)
    s_cbranch_scc1 L_th_35
    s_waitcnt vmcnt(2)
L_th_35:
    s_cmp_le_u32 s20, 5
    s_cbranch_scc1 L_th_36
    s_waitcnt vmcnt(1)
L_th_36:
    buffer_load_dwordx4 v[76:79], v2, s[8:11], s33 offen nt
    v_xor_b32 v2, 99328, v2
    s_cmp_gt_u32 s23, 6
    s_waitcnt vmcnt(3)
    s_cbranch_scc1 L_th_37
    s_waitcnt vmcnt(2)
L_th_37:
    s_cmp_le_u32 s20, 6
    s_cbranch_scc1 L_th_38
    s_waitcnt vmcnt(1)
L_th_38:
    buffer_load_dwordx4 v[80:83], v2, s[8:11], s33 offen nt
    v_xor_b32 v2, 67584, v2
    s_cmp_gt_u32 s23, 7
    s_waitcnt vmcnt(3)
    s_cbranch_scc1 L_th_39
    s_waitcnt vmcnt(2)
L_th_39:
    s_cmp_le_u32 s20, 7
    s_cbranch_scc1 L_th_40
    s_waitcnt vmcnt(1)
L_th_40:
    buffer_load_dwordx4 v[84:87], v2, s[8:11], s33 offen nt
    v_xor_b32 v2, 34816, v2
    s_cmp_gt_u32 s23, 8
    s_waitcnt vmcnt(3)
    s_cbranch_scc1 L_th_41
    s_waitcnt vmcnt(2)
L_th_41:
    s_cmp_le_u32 s20, 8
    s_cbranch_scc1 L_th_42
    s_waitcnt vmcnt(1)
L_th_42:
    buffer_load_dwordx4 v[88:91], v2, s[8:11], s33 offen nt
    v_xor_b32 v2, 67584, v2
    s_cmp_lg_u32 s21, 3
    s_cbranch_scc1 L_nokm
    v_mov_b32 v3, 0
    v_mov_b32 v4, 1
    ds_write_b32 v3, v4 offset:60
L_nokm:
    s_cmp_gt_u32 s23, 9
    s_waitcnt vmcnt(3)
    s_cbranch_scc1 L_th_43
    s_waitcnt vmcnt(2)
L_th_43:
    s_cmp_le_u32 s20, 9
    s_cbranch_scc1 L_th_44
    s_waitcnt vmcnt(1)
L_th_44:
    buffer_load_dwordx4 v[92:95], v2, s[8:11], s33 offen nt
    v_xor_b32 v2, 99328, v2
    s_cmp_gt_u32 s23, 10
    s_waitcnt vmcnt(3)
    s_cbranch_scc1 L_th_45
    s_waitcnt vmcnt(2)
L_th_45:
    s_cmp_le_u32 s20, 10
    s_cbranch_scc1 L_th_46
    s_waitcnt vmcnt(1)
L_th_46:
    buffer_load_dwordx4 v[96:99], v2, s[8:11], s33 offen nt
    v_xor_b32 v2, 67584, v2
    s_cmp_gt_u32 s23, 11
    s_waitcnt vmcnt(3)
    s_cbranch_scc1 L_th_47
    s_waitcnt vmcnt(2)
L_th_47:
    s_cmp_le_u32 s20, 11
    s_cbranch_scc1 L_th_48
    s_waitcnt vmcnt(1)
L_th_48:
    buffer_load_dwordx4 v[100:103], v2, s[8:11], s33 offen nt
    v_xor_b32 v2, 196608, v2
    s_cmp_gt_u32 s23, 12
    s_waitcnt vmcnt(3)
    s_cbranch_scc1 L_th_49
    s_waitcnt vmcnt(2)
L_th_49:
    s_cmp_le_u32 s20, 12
    s_cbranch_scc1 L_th_50
    s_waitcnt vmcnt(1)
L_th_50:
    buffer_load_dwordx4 v[104:107], v2, s[8:11], s33 offen nt
    v_xor_b32 v2, 67584, v2
    s_cmp_gt_u32 s23, 13
    s_waitcnt vmcnt(3)
    s_cbranch_scc1 L_th_51
    s_waitcnt vmcnt(2)
L_th_51:
    buffer_load_dwordx4 v[108:111], v2, s[8:11], s33 offen nt
    v_xor_b32 v2, 99328, v2
    s_cmp_gt_u32 s23, 14
    s_waitcnt vmcnt(3)
    s_cbranch_scc1 L_th_52
    s_waitcnt vmcnt(2)
L_th_52:
    buffer_load_dwordx4 v[112:115], v2, s[8:11], s33 offen nt
    v_xor_b32 v2, 67584, v2
    s_cmp_gt_u32 s23, 15
    s_waitcnt vmcnt(3)
    s_cbranch_scc1 L_th_53
    s_waitcnt vmcnt(2)
L_th_53:
    buffer_load_dwordx4 v[116:119], v2, s[8:11], s33 offen nt
    v_xor_b32 v2, 34816, v2
    s_cmp_gt_u32 s23, 16
    s_waitcnt vmcnt(3)
    s_cbranch_scc1 L_th_54
    s_waitcnt vmcnt(2)
L_th_54:
    buffer_load_dwordx4 v[120:123], v2, s[8:11], s33 offen nt
    v_xor_b32 v2, 67584, v2
    s_cmp_gt_u32 s23, 17
    s_waitcnt vmcnt(3)
    s_cbranch_scc1 L_th_55
    s_waitcnt vmcnt(2)
L_th_55:
    buffer_load_dwordx4 v[124:127], v2, s[8:11], s33 offen nt
    v_xor_b32 v2, 99328, v2
    s_cmp_gt_u32 s23, 18
    s_waitcnt vmcnt(3)
    s_cbranch_scc1 L_th_56
    s_waitcnt vmcnt(2)
L_th_56:
    buffer_load_dwordx4 v[128:131], v2, s[8:11], s33 offen nt
    v_xor_b32 v2, 67584, v2
    s_cmp_gt_u32 s23, 19
    s_waitcnt vmcnt(3)
    s_cbranch_scc1 L_th_57
    s_waitcnt vmcnt(2)
L_th_57:
    buffer_load_dwordx4 v[132:135], v2, s[8:11], s33 offen nt
    v_xor_b32 v2, 33792, v2
    s_cmp_gt_u32 s23, 20
    s_waitcnt vmcnt(3)
    s_cbranch_scc1 L_th_58
    s_waitcnt vmcnt(2)
L_th_58:
    buffer_load_dwordx4 v[136:139], v2, s[8:11], s33 offen nt
    v_xor_b32 v2, 67584, v2
    s_cmp_gt_u32 s23, 21
    s_waitcnt vmcnt(3)
    s_cbranch_scc1 L_th_59
    s_waitcnt vmcnt(2)
L_th_59:
    buffer_load_dwordx4 v[140:143], v2, s[8:11], s33 offen nt
    v_xor_b32 v2, 99328, v2
    s_cmp_gt_u32 s23, 22
    s_waitcnt vmcnt(3)
    s_cbranch_scc1 L_th_60
    s_waitcnt vmcnt(2)
L_th_60:
    buffer_load_dwordx4 v[144:147], v2, s[8:11], s33 offen nt
    v_xor_b32 v2, 67584, v2
    s_cmp_gt_u32 s23, 23
    s_waitcnt vmcnt(3)
    s_cbranch_scc1 L_th_61
    s_waitcnt vmcnt(2)
L_th_61:
    buffer_load_dwordx4 v[148:151], v2, s[8:11], s33 offen nt
    v_xor_b32 v2, 34816, v2
    s_cmp_gt_u32 s23, 24
    s_waitcnt vmcnt(3)
    s_cbranch_scc1 L_th_62
    s_waitcnt vmcnt(2)
L_th_62:
    buffer_load_dwordx4 v[152:155], v2, s[8:11], s33 offen nt
    v_xor_b32 v2, 67584, v2
    s_cmp_gt_u32 s23, 25
    s_waitcnt vmcnt(3)
    s_cbranch_scc1 L_th_63
    s_waitcnt vmcnt(2)
L_th_63:
    buffer_load_dwordx4 v[156:159], v2, s[8:11], s33 offen nt
    v_xor_b32 v2, 99328, v2
    s_cmp_gt_u32 s23, 26
    s_waitcnt vmcnt(3)
    s_cbranch_scc1 L_th_64
    s_waitcnt vmcnt(2)
L_th_64:
    buffer_load_dwordx4 v[160:163], v2, s[8:11], s33 offen nt
    v_xor_b32 v2, 67584, v2
    s_cmp_gt_u32 s23, 27
    s_waitcnt vmcnt(3)
    s_cbranch_scc1 L_th_65
    s_waitcnt vmcnt(2)
L_th_65:
    buffer_load_dwordx4 v[164:167], v2, s[8:11], s33 offen nt
    v_mov_b32 v3, 0
    v_mov_b32 v4, 1
    ds_write_b32 v3, v4 offset:36
    s_mov_b32 s22, 16384
    s_cmp_lt_u32 s5, 9
    s_cselect_b32 s22, 90112, s22
    s_mul_i32 s28, s3, 6144
    s_add_u32 s22, s22, s28
    s_add_u32 m0, s22, 0
    s_cmp_gt_u32 s23, 28
    s_waitcnt vmcnt(3)
    s_cbranch_scc1 L_th_66
    s_waitcnt vmcnt(2)
L_th_66:
    buffer_load_dwordx4 v1, s[12:15], s33 offen nt lds
    v_xor_b32 v1, 67584, v1
    s_add_u32 m0, s22, 1024
    s_cmp_gt_u32 s23, 29
    s_waitcnt vmcnt(3)
    s_cbranch_scc1 L_th_67
    s_waitcnt vmcnt(2)
L_th_67:
    buffer_load_dwordx4 v1, s[12:15], s33 offen nt lds
    v_xor_b32 v1, 99328, v1
    s_add_u32 m0, s22, 2048
    s_cmp_gt_u32 s23, 30
    s_waitcnt vmcnt(3)
    s_cbranch_scc1 L_th_68
    s_waitcnt vmcnt(2)
L_th_68:
    buffer_load_dwordx4 v1, s[12:15], s33 offen nt lds
    v_xor_b32 v1, 67584, v1
    s_add_u32 m0, s22, 3072
    s_cmp_gt_u32 s23, 31
    s_waitcnt vmcnt(3)
    s_cbranch_scc1 L_th_69
    s_waitcnt vmcnt(2)
L_th_69:
    buffer_load_dwordx4 v1, s[12:15], s33 offen nt lds
    v_xor_b32 v1, 34816, v1
    s_add_u32 m0, s22, 4096
    s_cmp_gt_u32 s23, 32
    s_waitcnt vmcnt(3)
    s_cbranch_scc1 L_th_70
    s_waitcnt vmcnt(2)
L_th_70:
    buffer_load_dwordx4 v1, s[12:15], s33 offen nt lds
    v_xor_b32 v1, 67584, v1
    s_add_u32 m0, s22, 5120
    s_cmp_gt_u32 s23, 33
    s_waitcnt vmcnt(3)
    s_cbranch_scc1 L_th_71
    s_waitcnt vmcnt(2)
L_th_71:
    buffer_load_dwordx4 v1, s[12:15], s33 offen nt lds
    v_xor_b32 v1, 99328, v1
    v_mov_b32 v2, 0
    s_mov_b32 s7, 0
L_lw_72:
    ds_read_b32 v3, v2 offset:4
    s_waitcnt lgkmcnt(0)
    v_readfirstlane_b32 s28, v3
    s_nop 0
    s_cmp_ge_u32 s28, 1
    s_cbranch_scc1 L_lwd_73
    s_sleep 2
    s_add_u32 s7, s7, 1
    s_cmp_lt_u32 s7, 1048576
    s_cbranch_scc1 L_lw_72
L_lwd_73:
    ds_read_b128 v[20:23], v36 offset:256
    s_mov_b32 s30, 1035273459
    s_mov_b32 s31, 1069066811
    v_mov_b32 v36, 0xff800000
    s_waitcnt lgkmcnt(0)
    s_mul_i32 s35, s34, 0x9E3779B1
    s_add_u32 s35, s35, 0x7F4A7C15
    s_mov_b32 s90, 0xfffff000
    v_mfma_f32_16x16x32_bf16 v[40:43], v[40:43], v[20:23], 0
    v_mfma_f32_16x16x32_bf16 v[44:47], v[44:47], v[20:23], 0
    v_mfma_f32_16x16x32_bf16 v[48:51], v[48:51], v[20:23], 0
    v_mfma_f32_16x16x32_bf16 v[52:55], v[52:55], v[20:23], 0
    v_mfma_f32_16x16x32_bf16 v[56:59], v[56:59], v[20:23], 0
    v_mfma_f32_16x16x32_bf16 v[60:63], v[60:63], v[20:23], 0
    v_mfma_f32_16x16x32_bf16 v[64:67], v[64:67], v[20:23], 0
    v_mfma_f32_16x16x32_bf16 v[68:71], v[68:71], v[20:23], 0
    s_nop 0
    v_mov_b32_dpp v24, v40 quad_perm:[0,0,0,0] row_mask:0xf bank_mask:0xf
    v_mov_b32_dpp v25, v44 quad_perm:[0,0,0,0] row_mask:0xf bank_mask:0xf
    v_mov_b32_dpp v26, v48 quad_perm:[0,0,0,0] row_mask:0xf bank_mask:0xf
    v_mov_b32_dpp v27, v52 quad_perm:[0,0,0,0] row_mask:0xf bank_mask:0xf
    v_add_f32_dpp v24, v41, v24 quad_perm:[1,1,1,1] row_mask:0xf bank_mask:0xf
    v_add_f32_dpp v25, v45, v25 quad_perm:[1,1,1,1] row_mask:0xf bank_mask:0xf
    v_add_f32_dpp v26, v49, v26 quad_perm:[1,1,1,1] row_mask:0xf bank_mask:0xf
    v_add_f32_dpp v27, v53, v27 quad_perm:[1,1,1,1] row_mask:0xf bank_mask:0xf
    v_add_f32_dpp v24, v42, v24 quad_perm:[2,2,2,2] row_mask:0xf bank_mask:0xf
    v_add_f32_dpp v25, v46, v25 quad_perm:[2,2,2,2] row_mask:0xf bank_mask:0xf
    v_add_f32_dpp v26, v50, v26 quad_perm:[2,2,2,2] row_mask:0xf bank_mask:0xf
    v_add_f32_dpp v27, v54, v27 quad_perm:[2,2,2,2] row_mask:0xf bank_mask:0xf
    v_add_f32_dpp v24, v43, v24 quad_perm:[3,3,3,3] row_mask:0xf bank_mask:0xf
    v_add_f32_dpp v25, v47, v25 quad_perm:[3,3,3,3] row_mask:0xf bank_mask:0xf
    v_add_f32_dpp v26, v51, v26 quad_perm:[3,3,3,3] row_mask:0xf bank_mask:0xf
    v_add_f32_dpp v27, v55, v27 quad_perm:[3,3,3,3] row_mask:0xf bank_mask:0xf
    v_cvt_pk_bf16_f32 v28, v24, v25
    v_cvt_pk_bf16_f32 v29, v26, v27
    v_lshlrev_b32 v24, 16, v28
    v_and_b32 v25, 0xffff0000, v28
    v_lshlrev_b32 v26, 16, v29
    v_and_b32 v27, 0xffff0000, v29
    v_mul_f32 v24, s30, v24
    v_mul_f32 v25, s30, v25
    v_mul_f32 v26, s30, v26
    v_mul_f32 v27, s30, v27
    v_cvt_pk_bf16_f32 v4, v24, v25
    v_cvt_pk_bf16_f32 v5, v26, v27
    v_max3_f32 v36, v24, v25, v36
    v_max3_f32 v36, v26, v27, v36
    s_cmp_gt_u32 s23, 34
    s_waitcnt vmcnt(3)
    s_cbranch_scc1 L_th_74
    s_waitcnt vmcnt(2)
L_th_74:
    buffer_load_dwordx4 v[40:43], v1, s[12:15], s33 offen nt
    v_xor_b32 v1, 67584, v1
    s_cmp_gt_u32 s23, 35
    s_waitcnt vmcnt(3)
    s_cbranch_scc1 L_th_75
    s_waitcnt vmcnt(2)
L_th_75:
    buffer_load_dwordx4 v[44:47], v1, s[12:15], s33 offen nt
    v_xor_b32 v1, 33792, v1
    v_mfma_f32_16x16x32_bf16 v[72:75], v[72:75], v[20:23], 0
    v_mfma_f32_16x16x32_bf16 v[76:79], v[76:79], v[20:23], 0
    v_mfma_f32_16x16x32_bf16 v[80:83], v[80:83], v[20:23], 0
    v_mfma_f32_16x16x32_bf16 v[84:87], v[84:87], v[20:23], 0
    v_mov_b32_dpp v24, v56 quad_perm:[0,0,0,0] row_mask:0xf bank_mask:0xf
    v_mov_b32_dpp v25, v60 quad_perm:[0,0,0,0] row_mask:0xf bank_mask:0xf
    v_mov_b32_dpp v26, v64 quad_perm:[0,0,0,0] row_mask:0xf bank_mask:0xf
    v_mov_b32_dpp v27, v68 quad_perm:[0,0,0,0] row_mask:0xf bank_mask:0xf
    v_add_f32_dpp v24, v57, v24 quad_perm:[1,1,1,1] row_mask:0xf bank_mask:0xf
    v_add_f32_dpp v25, v61, v25 quad_perm:[1,1,1,1] row_mask:0xf bank_mask:0xf
    v_add_f32_dpp v26, v65, v26 quad_perm:[1,1,1,1] row_mask:0xf bank_mask:0xf
    v_add_f32_dpp v27, v69, v27 quad_perm:[1,1,1,1] row_mask:0xf bank_mask:0xf
    v_add_f32_dpp v24, v58, v24 quad_perm:[2,2,2,2] row_mask:0xf bank_mask:0xf
    v_add_f32_dpp v25, v62, v25 quad_perm:[2,2,2,2] row_mask:0xf bank_mask:0xf
    v_add_f32_dpp v26, v66, v26 quad_perm:[2,2,2,2] row_mask:0xf bank_mask:0xf
    v_add_f32_dpp v27, v70, v27 quad_perm:[2,2,2,2] row_mask:0xf bank_mask:0xf
    v_add_f32_dpp v24, v59, v24 quad_perm:[3,3,3,3] row_mask:0xf bank_mask:0xf
    v_add_f32_dpp v25, v63, v25 quad_perm:[3,3,3,3] row_mask:0xf bank_mask:0xf
    v_add_f32_dpp v26, v67, v26 quad_perm:[3,3,3,3] row_mask:0xf bank_mask:0xf
    v_add_f32_dpp v27, v71, v27 quad_perm:[3,3,3,3] row_mask:0xf bank_mask:0xf
    v_cvt_pk_bf16_f32 v28, v24, v25
    v_cvt_pk_bf16_f32 v29, v26, v27
    v_lshlrev_b32 v24, 16, v28
    v_and_b32 v25, 0xffff0000, v28
    v_lshlrev_b32 v26, 16, v29
    v_and_b32 v27, 0xffff0000, v29
    v_mul_f32 v24, s30, v24
    v_mul_f32 v25, s30, v25
    v_mul_f32 v26, s30, v26
    v_mul_f32 v27, s30, v27
    v_cvt_pk_bf16_f32 v6, v24, v25
    v_cvt_pk_bf16_f32 v7, v26, v27
    v_max3_f32 v36, v24, v25, v36
    v_max3_f32 v36, v26, v27, v36
    v_mfma_f32_16x16x32_bf16 v[88:91], v[88:91], v[20:23], 0
    v_mfma_f32_16x16x32_bf16 v[92:95], v[92:95], v[20:23], 0
    v_mfma_f32_16x16x32_bf16 v[96:99], v[96:99], v[20:23], 0
    v_mfma_f32_16x16x32_bf16 v[100:103], v[100:103], v[20:23], 0
    v_mov_b32_dpp v24, v72 quad_perm:[0,0,0,0] row_mask:0xf bank_mask:0xf
    v_mov_b32_dpp v25, v76 quad_perm:[0,0,0,0] row_mask:0xf bank_mask:0xf
    v_mov_b32_dpp v26, v80 quad_perm:[0,0,0,0] row_mask:0xf bank_mask:0xf
    v_mov_b32_dpp v27, v84 quad_perm:[0,0,0,0] row_mask:0xf bank_mask:0xf
    v_add_f32_dpp v24, v73, v24 quad_perm:[1,1,1,1] row_mask:0xf bank_mask:0xf
    v_add_f32_dpp v25, v77, v25 quad_perm:[1,1,1,1] row_mask:0xf bank_mask:0xf
    v_add_f32_dpp v26, v81, v26 quad_perm:[1,1,1,1] row_mask:0xf bank_mask:0xf
    v_add_f32_dpp v27, v85, v27 quad_perm:[1,1,1,1] row_mask:0xf bank_mask:0xf
    v_add_f32_dpp v24, v74, v24 quad_perm:[2,2,2,2] row_mask:0xf bank_mask:0xf
    v_add_f32_dpp v25, v78, v25 quad_perm:[2,2,2,2] row_mask:0xf bank_mask:0xf
    v_add_f32_dpp v26, v82, v26 quad_perm:[2,2,2,2] row_mask:0xf bank_mask:0xf
    v_add_f32_dpp v27, v86, v27 quad_perm:[2,2,2,2] row_mask:0xf bank_mask:0xf
    v_add_f32_dpp v24, v75, v24 quad_perm:[3,3,3,3] row_mask:0xf bank_mask:0xf
    v_add_f32_dpp v25, v79, v25 quad_perm:[3,3,3,3] row_mask:0xf bank_mask:0xf
    v_add_f32_dpp v26, v83, v26 quad_perm:[3,3,3,3] row_mask:0xf bank_mask:0xf
    v_add_f32_dpp v27, v87, v27 quad_perm:[3,3,3,3] row_mask:0xf bank_mask:0xf
    v_cvt_pk_bf16_f32 v28, v24, v25
    v_cvt_pk_bf16_f32 v29, v26, v27
    v_lshlrev_b32 v24, 16, v28
    v_and_b32 v25, 0xffff0000, v28
    v_lshlrev_b32 v26, 16, v29
    v_and_b32 v27, 0xffff0000, v29
    v_mul_f32 v24, s30, v24
    v_mul_f32 v25, s30, v25
    v_mul_f32 v26, s30, v26
    v_mul_f32 v27, s30, v27
    v_cvt_pk_bf16_f32 v8, v24, v25
    v_cvt_pk_bf16_f32 v9, v26, v27
    v_max3_f32 v36, v24, v25, v36
    v_max3_f32 v36, v26, v27, v36
    s_cmp_gt_u32 s23, 36
    s_waitcnt vmcnt(3)
    s_cbranch_scc1 L_th_76
    s_waitcnt vmcnt(2)
L_th_76:
    buffer_load_dwordx4 v[48:51], v1, s[12:15], s33 offen nt
    v_xor_b32 v1, 67584, v1
    v_mfma_f32_16x16x32_bf16 v[104:107], v[104:107], v[20:23], 0
    v_mfma_f32_16x16x32_bf16 v[108:111], v[108:111], v[20:23], 0
    v_mfma_f32_16x16x32_bf16 v[112:115], v[112:115], v[20:23], 0
    v_mfma_f32_16x16x32_bf16 v[116:119], v[116:119], v[20:23], 0
    v_mov_b32_dpp v24, v88 quad_perm:[0,0,0,0] row_mask:0xf bank_mask:0xf
    v_mov_b32_dpp v25, v92 quad_perm:[0,0,0,0] row_mask:0xf bank_mask:0xf
    v_mov_b32_dpp v26, v96 quad_perm:[0,0,0,0] row_mask:0xf bank_mask:0xf
    v_mov_b32_dpp v27, v100 quad_perm:[0,0,0,0] row_mask:0xf bank_mask:0xf
    v_add_f32_dpp v24, v89, v24 quad_perm:[1,1,1,1] row_mask:0xf bank_mask:0xf
    v_add_f32_dpp v25, v93, v25 quad_perm:[1,1,1,1] row_mask:0xf bank_mask:0xf
    v_add_f32_dpp v26, v97, v26 quad_perm:[1,1,1,1] row_mask:0xf bank_mask:0xf
    v_add_f32_dpp v27, v101, v27 quad_perm:[1,1,1,1] row_mask:0xf bank_mask:0xf
    v_add_f32_dpp v24, v90, v24 quad_perm:[2,2,2,2] row_mask:0xf bank_mask:0xf
    v_add_f32_dpp v25, v94, v25 quad_perm:[2,2,2,2] row_mask:0xf bank_mask:0xf
    v_add_f32_dpp v26, v98, v26 quad_perm:[2,2,2,2] row_mask:0xf bank_mask:0xf
    v_add_f32_dpp v27, v102, v27 quad_perm:[2,2,2,2] row_mask:0xf bank_mask:0xf
    v_add_f32_dpp v24, v91, v24 quad_perm:[3,3,3,3] row_mask:0xf bank_mask:0xf
    v_add_f32_dpp v25, v95, v25 quad_perm:[3,3,3,3] row_mask:0xf bank_mask:0xf
    v_add_f32_dpp v26, v99, v26 quad_perm:[3,3,3,3] row_mask:0xf bank_mask:0xf
    v_add_f32_dpp v27, v103, v27 quad_perm:[3,3,3,3] row_mask:0xf bank_mask:0xf
    v_cvt_pk_bf16_f32 v28, v24, v25
    v_cvt_pk_bf16_f32 v29, v26, v27
    v_lshlrev_b32 v24, 16, v28
    v_and_b32 v25, 0xffff0000, v28
    v_lshlrev_b32 v26, 16, v29
    v_and_b32 v27, 0xffff0000, v29
    v_mul_f32 v24, s30, v24
    v_mul_f32 v25, s30, v25
    v_mul_f32 v26, s30, v26
    v_mul_f32 v27, s30, v27
    v_cvt_pk_bf16_f32 v10, v24, v25
    v_cvt_pk_bf16_f32 v11, v26, v27
    v_max3_f32 v36, v24, v25, v36
    v_max3_f32 v36, v26, v27, v36
    v_mfma_f32_16x16x32_bf16 v[120:123], v[120:123], v[20:23], 0
    v_mfma_f32_16x16x32_bf16 v[124:127], v[124:127], v[20:23], 0
    v_mfma_f32_16x16x32_bf16 v[128:131], v[128:131], v[20:23], 0
    v_mfma_f32_16x16x32_bf16 v[132:135], v[132:135], v[20:23], 0
    v_mov_b32_dpp v24, v104 quad_perm:[0,0,0,0] row_mask:0xf bank_mask:0xf
    v_mov_b32_dpp v25, v108 quad_perm:[0,0,0,0] row_mask:0xf bank_mask:0xf
    v_mov_b32_dpp v26, v112 quad_perm:[0,0,0,0] row_mask:0xf bank_mask:0xf
    v_mov_b32_dpp v27, v116 quad_perm:[0,0,0,0] row_mask:0xf bank_mask:0xf
    v_add_f32_dpp v24, v105, v24 quad_perm:[1,1,1,1] row_mask:0xf bank_mask:0xf
    v_add_f32_dpp v25, v109, v25 quad_perm:[1,1,1,1] row_mask:0xf bank_mask:0xf
    v_add_f32_dpp v26, v113, v26 quad_perm:[1,1,1,1] row_mask:0xf bank_mask:0xf
    v_add_f32_dpp v27, v117, v27 quad_perm:[1,1,1,1] row_mask:0xf bank_mask:0xf
    v_add_f32_dpp v24, v106, v24 quad_perm:[2,2,2,2] row_mask:0xf bank_mask:0xf
    v_add_f32_dpp v25, v110, v25 quad_perm:[2,2,2,2] row_mask:0xf bank_mask:0xf
    v_add_f32_dpp v26, v114, v26 quad_perm:[2,2,2,2] row_mask:0xf bank_mask:0xf
    v_add_f32_dpp v27, v118, v27 quad_perm:[2,2,2,2] row_mask:0xf bank_mask:0xf
    v_add_f32_dpp v24, v107, v24 quad_perm:[3,3,3,3] row_mask:0xf bank_mask:0xf
    v_add_f32_dpp v25, v111, v25 quad_perm:[3,3,3,3] row_mask:0xf bank_mask:0xf
    v_add_f32_dpp v26, v115, v26 quad_perm:[3,3,3,3] row_mask:0xf bank_mask:0xf
    v_add_f32_dpp v27, v119, v27 quad_perm:[3,3,3,3] row_mask:0xf bank_mask:0xf
    v_cvt_pk_bf16_f32 v28, v24, v25
    v_cvt_pk_bf16_f32 v29, v26, v27
    v_lshlrev_b32 v24, 16, v28
    v_and_b32 v25, 0xffff0000, v28
    v_lshlrev_b32 v26, 16, v29
    v_and_b32 v27, 0xffff0000, v29
    v_mul_f32 v24, s30, v24
    v_mul_f32 v25, s30, v25
    v_mul_f32 v26, s30, v26
    v_mul_f32 v27, s30, v27
    v_cvt_pk_bf16_f32 v12, v24, v25
    v_cvt_pk_bf16_f32 v13, v26, v27
    v_max3_f32 v36, v24, v25, v36
    v_max3_f32 v36, v26, v27, v36
    s_cmp_gt_u32 s23, 37
    s_waitcnt vmcnt(3)
    s_cbranch_scc1 L_th_77
    s_waitcnt vmcnt(2)
L_th_77:
    buffer_load_dwordx4 v[52:55], v1, s[12:15], s33 offen nt
    v_xor_b32 v1, 99328, v1
    v_mfma_f32_16x16x32_bf16 v[136:139], v[136:139], v[20:23], 0
    v_mfma_f32_16x16x32_bf16 v[140:143], v[140:143], v[20:23], 0
    v_mfma_f32_16x16x32_bf16 v[144:147], v[144:147], v[20:23], 0
    v_mfma_f32_16x16x32_bf16 v[148:151], v[148:151], v[20:23], 0
    v_mov_b32_dpp v24, v120 quad_perm:[0,0,0,0] row_mask:0xf bank_mask:0xf
    v_mov_b32_dpp v25, v124 quad_perm:[0,0,0,0] row_mask:0xf bank_mask:0xf
    v_mov_b32_dpp v26, v128 quad_perm:[0,0,0,0] row_mask:0xf bank_mask:0xf
    v_mov_b32_dpp v27, v132 quad_perm:[0,0,0,0] row_mask:0xf bank_mask:0xf
    v_add_f32_dpp v24, v121, v24 quad_perm:[1,1,1,1] row_mask:0xf bank_mask:0xf
    v_add_f32_dpp v25, v125, v25 quad_perm:[1,1,1,1] row_mask:0xf bank_mask:0xf
    v_add_f32_dpp v26, v129, v26 quad_perm:[1,1,1,1] row_mask:0xf bank_mask:0xf
    v_add_f32_dpp v27, v133, v27 quad_perm:[1,1,1,1] row_mask:0xf bank_mask:0xf
    v_add_f32_dpp v24, v122, v24 quad_perm:[2,2,2,2] row_mask:0xf bank_mask:0xf
    v_add_f32_dpp v25, v126, v25 quad_perm:[2,2,2,2] row_mask:0xf bank_mask:0xf
    v_add_f32_dpp v26, v130, v26 quad_perm:[2,2,2,2] row_mask:0xf bank_mask:0xf
    v_add_f32_dpp v27, v134, v27 quad_perm:[2,2,2,2] row_mask:0xf bank_mask:0xf
    v_add_f32_dpp v24, v123, v24 quad_perm:[3,3,3,3] row_mask:0xf bank_mask:0xf
    v_add_f32_dpp v25, v127, v25 quad_perm:[3,3,3,3] row_mask:0xf bank_mask:0xf
    v_add_f32_dpp v26, v131, v26 quad_perm:[3,3,3,3] row_mask:0xf bank_mask:0xf
    v_add_f32_dpp v27, v135, v27 quad_perm:[3,3,3,3] row_mask:0xf bank_mask:0xf
    v_cvt_pk_bf16_f32 v28, v24, v25
    v_cvt_pk_bf16_f32 v29, v26, v27
    v_lshlrev_b32 v24, 16, v28
    v_and_b32 v25, 0xffff0000, v28
    v_lshlrev_b32 v26, 16, v29
    v_and_b32 v27, 0xffff0000, v29
    v_mul_f32 v24, s30, v24
    v_mul_f32 v25, s30, v25
    v_mul_f32 v26, s30, v26
    v_mul_f32 v27, s30, v27
    v_cvt_pk_bf16_f32 v14, v24, v25
    v_cvt_pk_bf16_f32 v15, v26, v27
    v_max3_f32 v36, v24, v25, v36
    v_max3_f32 v36, v26, v27, v36
    s_waitcnt vmcnt(10)
    v_mfma_f32_16x16x32_bf16 v[152:155], v[152:155], v[20:23], 0
    v_mfma_f32_16x16x32_bf16 v[156:159], v[156:159], v[20:23], 0
    v_mfma_f32_16x16x32_bf16 v[160:163], v[160:163], v[20:23], 0
    v_mfma_f32_16x16x32_bf16 v[164:167], v[164:167], v[20:23], 0
    v_mov_b32_dpp v24, v136 quad_perm:[0,0,0,0] row_mask:0xf bank_mask:0xf
    v_mov_b32_dpp v25, v140 quad_perm:[0,0,0,0] row_mask:0xf bank_mask:0xf
    v_mov_b32_dpp v26, v144 quad_perm:[0,0,0,0] row_mask:0xf bank_mask:0xf
    v_mov_b32_dpp v27, v148 quad_perm:[0,0,0,0] row_mask:0xf bank_mask:0xf
    v_add_f32_dpp v24, v137, v24 quad_perm:[1,1,1,1] row_mask:0xf bank_mask:0xf
    v_add_f32_dpp v25, v141, v25 quad_perm:[1,1,1,1] row_mask:0xf bank_mask:0xf
    v_add_f32_dpp v26, v145, v26 quad_perm:[1,1,1,1] row_mask:0xf bank_mask:0xf
    v_add_f32_dpp v27, v149, v27 quad_perm:[1,1,1,1] row_mask:0xf bank_mask:0xf
    v_add_f32_dpp v24, v138, v24 quad_perm:[2,2,2,2] row_mask:0xf bank_mask:0xf
    v_add_f32_dpp v25, v142, v25 quad_perm:[2,2,2,2] row_mask:0xf bank_mask:0xf
    v_add_f32_dpp v26, v146, v26 quad_perm:[2,2,2,2] row_mask:0xf bank_mask:0xf
    v_add_f32_dpp v27, v150, v27 quad_perm:[2,2,2,2] row_mask:0xf bank_mask:0xf
    v_add_f32_dpp v24, v139, v24 quad_perm:[3,3,3,3] row_mask:0xf bank_mask:0xf
    v_add_f32_dpp v25, v143, v25 quad_perm:[3,3,3,3] row_mask:0xf bank_mask:0xf
    v_add_f32_dpp v26, v147, v26 quad_perm:[3,3,3,3] row_mask:0xf bank_mask:0xf
    v_add_f32_dpp v27, v151, v27 quad_perm:[3,3,3,3] row_mask:0xf bank_mask:0xf
    v_cvt_pk_bf16_f32 v28, v24, v25
    v_cvt_pk_bf16_f32 v29, v26, v27
    v_lshlrev_b32 v24, 16, v28
    v_and_b32 v25, 0xffff0000, v28
    v_lshlrev_b32 v26, 16, v29
    v_and_b32 v27, 0xffff0000, v29
    v_mul_f32 v24, s30, v24
    v_mul_f32 v25, s30, v25
    v_mul_f32 v26, s30, v26
    v_mul_f32 v27, s30, v27
    v_cvt_pk_bf16_f32 v16, v24, v25
    v_cvt_pk_bf16_f32 v17, v26, v27
    v_max3_f32 v36, v24, v25, v36
    v_max3_f32 v36, v26, v27, v36
    s_cmp_gt_u32 s23, 38
    s_waitcnt vmcnt(3)
    s_cbranch_scc1 L_th_78
    s_waitcnt vmcnt(2)
L_th_78:
    buffer_load_dwordx4 v[56:59], v1, s[12:15], s33 offen nt
    v_xor_b32 v1, 67584, v1
    v_mov_b32_dpp v24, v152 quad_perm:[0,0,0,0] row_mask:0xf bank_mask:0xf
    v_mov_b32_dpp v25, v156 quad_perm:[0,0,0,0] row_mask:0xf bank_mask:0xf
    v_mov_b32_dpp v26, v160 quad_perm:[0,0,0,0] row_mask:0xf bank_mask:0xf
    v_mov_b32_dpp v27, v164 quad_perm:[0,0,0,0] row_mask:0xf bank_mask:0xf
    v_add_f32_dpp v24, v153, v24 quad_perm:[1,1,1,1] row_mask:0xf bank_mask:0xf
    v_add_f32_dpp v25, v157, v25 quad_perm:[1,1,1,1] row_mask:0xf bank_mask:0xf
    v_add_f32_dpp v26, v161, v26 quad_perm:[1,1,1,1] row_mask:0xf bank_mask:0xf
    v_add_f32_dpp v27, v165, v27 quad_perm:[1,1,1,1] row_mask:0xf bank_mask:0xf
    v_add_f32_dpp v24, v154, v24 quad_perm:[2,2,2,2] row_mask:0xf bank_mask:0xf
    v_add_f32_dpp v25, v158, v25 quad_perm:[2,2,2,2] row_mask:0xf bank_mask:0xf
    v_add_f32_dpp v26, v162, v26 quad_perm:[2,2,2,2] row_mask:0xf bank_mask:0xf
    v_add_f32_dpp v27, v166, v27 quad_perm:[2,2,2,2] row_mask:0xf bank_mask:0xf
    v_add_f32_dpp v24, v155, v24 quad_perm:[3,3,3,3] row_mask:0xf bank_mask:0xf
    v_add_f32_dpp v25, v159, v25 quad_perm:[3,3,3,3] row_mask:0xf bank_mask:0xf
    v_add_f32_dpp v26, v163, v26 quad_perm:[3,3,3,3] row_mask:0xf bank_mask:0xf
    v_add_f32_dpp v27, v167, v27 quad_perm:[3,3,3,3] row_mask:0xf bank_mask:0xf
    v_cvt_pk_bf16_f32 v28, v24, v25
    v_cvt_pk_bf16_f32 v29, v26, v27
    v_lshlrev_b32 v24, 16, v28
    v_and_b32 v25, 0xffff0000, v28
    v_lshlrev_b32 v26, 16, v29
    v_and_b32 v27, 0xffff0000, v29
    v_mul_f32 v24, s30, v24
    v_mul_f32 v25, s30, v25
    v_mul_f32 v26, s30, v26
    v_mul_f32 v27, s30, v27
    v_cvt_pk_bf16_f32 v18, v24, v25
    v_cvt_pk_bf16_f32 v19, v26, v27
    v_max3_f32 v36, v24, v25, v36
    v_max3_f32 v36, v26, v27, v36
    s_waitcnt vmcnt(5)
    v_lshl_add_u32 v3, v0, 4, s22
    ds_read_b128 v[144:147], v3 offset:0
    ds_read_b128 v[148:151], v3 offset:1024
    ds_read_b128 v[152:155], v3 offset:2048
    ds_read_b128 v[156:159], v3 offset:3072
    ds_read_b128 v[160:163], v3 offset:4096
    ds_read_b128 v[164:167], v3 offset:5120
    v_mov_b32 v24, v36
    s_nop 1
    v_permlane16_swap_b32 v36, v24
    v_max_f32 v36, v36, v24
    v_mov_b32 v24, v36
    s_nop 1
    v_permlane32_swap_b32 v36, v24
    v_max_f32 v36, v36, v24
    v_cvt_pk_bf16_f32 v36, v36, v36
    v_and_b32 v36, 0xffff0000, v36
    v_mul_f32 v37, s31, v36
    v_mov_b32 v38, 0
    v_mov_b32 v39, 0
    v_lshlrev_b32 v24, 16, v4
    v_and_b32 v25, 0xffff0000, v4
    v_fma_f32 v24, v24, s31, -v37
    v_fma_f32 v25, v25, s31, -v37
    v_exp_f32 v24, v24
    v_exp_f32 v25, v25
    v_add_f32 v38, v38, v24
    v_add_f32 v39, v39, v25
    v_cvt_pk_bf16_f32 v4, v24, v25
    v_lshlrev_b32 v24, 16, v5
    v_and_b32 v25, 0xffff0000, v5
    v_fma_f32 v24, v24, s31, -v37
    v_fma_f32 v25, v25, s31, -v37
    v_exp_f32 v24, v24
    v_exp_f32 v25, v25
    v_add_f32 v38, v38, v24
    v_add_f32 v39, v39, v25
    v_cvt_pk_bf16_f32 v5, v24, v25
    s_cmp_gt_u32 s23, 39
    s_waitcnt vmcnt(3)
    s_cbranch_scc1 L_th_79
    s_waitcnt vmcnt(2)
L_th_79:
    buffer_load_dwordx4 v[60:63], v1, s[12:15], s33 offen nt
    v_xor_b32 v1, 34816, v1
    v_lshlrev_b32 v24, 16, v6
    v_and_b32 v25, 0xffff0000, v6
    v_fma_f32 v24, v24, s31, -v37
    v_fma_f32 v25, v25, s31, -v37
    v_exp_f32 v24, v24
    v_exp_f32 v25, v25
    v_add_f32 v38, v38, v24
    v_add_f32 v39, v39, v25
    v_cvt_pk_bf16_f32 v6, v24, v25
    v_lshlrev_b32 v24, 16, v7
    v_and_b32 v25, 0xffff0000, v7
    v_fma_f32 v24, v24, s31, -v37
    v_fma_f32 v25, v25, s31, -v37
    v_exp_f32 v24, v24
    v_exp_f32 v25, v25
    v_add_f32 v38, v38, v24
    v_add_f32 v39, v39, v25
    v_cvt_pk_bf16_f32 v7, v24, v25
    v_lshlrev_b32 v24, 16, v8
    v_and_b32 v25, 0xffff0000, v8
    v_fma_f32 v24, v24, s31, -v37
    v_fma_f32 v25, v25, s31, -v37
    v_exp_f32 v24, v24
    v_exp_f32 v25, v25
    v_add_f32 v38, v38, v24
    v_add_f32 v39, v39, v25
    v_cvt_pk_bf16_f32 v8, v24, v25
    v_lshlrev_b32 v24, 16, v9
    v_and_b32 v25, 0xffff0000, v9
    v_fma_f32 v24, v24, s31, -v37
    v_fma_f32 v25, v25, s31, -v37
    v_exp_f32 v24, v24
    v_exp_f32 v25, v25
    v_add_f32 v38, v38, v24
    v_add_f32 v39, v39, v25
    v_cvt_pk_bf16_f32 v9, v24, v25
    v_lshlrev_b32 v24, 16, v10
    v_and_b32 v25, 0xffff0000, v10
    v_fma_f32 v24, v24, s31, -v37
    v_fma_f32 v25, v25, s31, -v37
    v_exp_f32 v24, v24
    v_exp_f32 v25, v25
    v_add_f32 v38, v38, v24
    v_add_f32 v39, v39, v25
    v_cvt_pk_bf16_f32 v10, v24, v25
    v_lshlrev_b32 v24, 16, v11
    v_and_b32 v25, 0xffff0000, v11
    v_fma_f32 v24, v24, s31, -v37
    v_fma_f32 v25, v25, s31, -v37
    v_exp_f32 v24, v24
    v_exp_f32 v25, v25
    v_add_f32 v38, v38, v24
    v_add_f32 v39, v39, v25
    v_cvt_pk_bf16_f32 v11, v24, v25
    s_cmp_gt_u32 s23, 40
    s_waitcnt vmcnt(3)
    s_cbranch_scc1 L_th_80
    s_waitcnt vmcnt(2)
L_th_80:
    buffer_load_dwordx4 v[64:67], v1, s[12:15], s33 offen nt
    v_xor_b32 v1, 67584, v1
    v_lshlrev_b32 v24, 16, v12
    v_and_b32 v25, 0xffff0000, v12
    v_fma_f32 v24, v24, s31, -v37
    v_fma_f32 v25, v25, s31, -v37
    v_exp_f32 v24, v24
    v_exp_f32 v25, v25
    v_add_f32 v38, v38, v24
    v_add_f32 v39, v39, v25
    v_cvt_pk_bf16_f32 v12, v24, v25
    v_lshlrev_b32 v24, 16, v13
    v_and_b32 v25, 0xffff0000, v13
    v_fma_f32 v24, v24, s31, -v37
    v_fma_f32 v25, v25, s31, -v37
    v_exp_f32 v24, v24
    v_exp_f32 v25, v25
    v_add_f32 v38, v38, v24
    v_add_f32 v39, v39, v25
    v_cvt_pk_bf16_f32 v13, v24, v25
    v_lshlrev_b32 v24, 16, v14
    v_and_b32 v25, 0xffff0000, v14
    v_fma_f32 v24, v24, s31, -v37
    v_fma_f32 v25, v25, s31, -v37
    v_exp_f32 v24, v24
    v_exp_f32 v25, v25
    v_add_f32 v38, v38, v24
    v_add_f32 v39, v39, v25
    v_cvt_pk_bf16_f32 v14, v24, v25
    v_lshlrev_b32 v24, 16, v15
    v_and_b32 v25, 0xffff0000, v15
    v_fma_f32 v24, v24, s31, -v37
    v_fma_f32 v25, v25, s31, -v37
    v_exp_f32 v24, v24
    v_exp_f32 v25, v25
    v_add_f32 v38, v38, v24
    v_add_f32 v39, v39, v25
    v_cvt_pk_bf16_f32 v15, v24, v25
    v_lshlrev_b32 v24, 16, v16
    v_and_b32 v25, 0xffff0000, v16
    v_fma_f32 v24, v24, s31, -v37
    v_fma_f32 v25, v25, s31, -v37
    v_exp_f32 v24, v24
    v_exp_f32 v25, v25
    v_add_f32 v38, v38, v24
    v_add_f32 v39, v39, v25
    v_cvt_pk_bf16_f32 v16, v24, v25
    v_lshlrev_b32 v24, 16, v17
    v_and_b32 v25, 0xffff0000, v17
    v_fma_f32 v24, v24, s31, -v37
    v_fma_f32 v25, v25, s31, -v37
    v_exp_f32 v24, v24
    v_exp_f32 v25, v25
    v_add_f32 v38, v38, v24
    v_add_f32 v39, v39, v25
    v_cvt_pk_bf16_f32 v17, v24, v25
    s_cmp_gt_u32 s23, 41
    s_waitcnt vmcnt(3)
    s_cbranch_scc1 L_th_81
    s_waitcnt vmcnt(2)
L_th_81:
    buffer_load_dwordx4 v[68:71], v1, s[12:15], s33 offen nt
    v_xor_b32 v1, 99328, v1
    v_lshlrev_b32 v24, 16, v18
    v_and_b32 v25, 0xffff0000, v18
    v_fma_f32 v24, v24, s31, -v37
    v_fma_f32 v25, v25, s31, -v37
    v_exp_f32 v24, v24
    v_exp_f32 v25, v25
    v_add_f32 v38, v38, v24
    v_add_f32 v39, v39, v25
    v_cvt_pk_bf16_f32 v18, v24, v25
    v_lshlrev_b32 v24, 16, v19
    v_and_b32 v25, 0xffff0000, v19
    v_fma_f32 v24, v24, s31, -v37
    v_fma_f32 v25, v25, s31, -v37
    v_exp_f32 v24, v24
    v_exp_f32 v25, v25
    v_add_f32 v38, v38, v24
    v_add_f32 v39, v39, v25
    v_cvt_pk_bf16_f32 v19, v24, v25
    v_add_f32 v37, v38, v39
    v_mov_b32 v24, v37
    s_nop 1
    v_permlane16_swap_b32 v37, v24
    v_add_f32 v37, v37, v24
    v_mov_b32 v24, v37
    s_nop 1
    v_permlane32_swap_b32 v37, v24
    v_add_f32 v37, v37, v24
    s_lshl_b32 s28, s3, 4
    v_add_u32 v3, s28, v0
    v_mov_b32 v24, 1
    s_mov_b64 exec, 0x101
    ds_write_b64 v3, v[36:37] offset:128
    s_mov_b64 exec, 1
    ds_add_u32 v2, v24 offset:8
    s_mov_b64 exec, -1
    v_and_b32 v3, 1, v0
    v_cmp_eq_u32 vcc, 1, v3
    v_mov_b32 v32, 0x0c0c0100
    v_mov_b32 v33, 0x01000c0c
    v_cndmask_b32 v32, v32, v33, vcc
    v_mov_b32 v34, 0x0c0c0302
    v_mov_b32 v33, 0x03020c0c
    v_cndmask_b32 v33, v34, v33, vcc
    v_bfe_u32 v3, v0, 1, 2
    v_mov_b32 v34, 0x0c0c0c0c
    v_cmp_eq_u32 vcc, 0, v3
    s_nop 1
    v_cndmask_b32 v24, v34, v32, vcc
    v_cndmask_b32 v28, v34, v33, vcc
    v_cmp_eq_u32 vcc, 1, v3
    s_nop 1
    v_cndmask_b32 v25, v34, v32, vcc
    v_cndmask_b32 v29, v34, v33, vcc
    v_cmp_eq_u32 vcc, 2, v3
    s_nop 1
    v_cndmask_b32 v26, v34, v32, vcc
    v_cndmask_b32 v30, v34, v33, vcc
    v_cmp_eq_u32 vcc, 3, v3
    s_nop 1
    v_cndmask_b32 v27, v34, v32, vcc
    v_cndmask_b32 v31, v34, v33, vcc
    v_and_b32 v3, 15, v0
    v_lshlrev_b32 v3, 5, v3
    v_bfe_u32 v2, v0, 4, 1
    v_lshl_add_u32 v3, v2, 4, v3
    v_lshrrev_b32 v2, 5, v0
    v_lshl_add_u32 v3, v2, 9, v3
    s_lshl_b32 s28, s3, 10
    v_add_u32 v3, s28, v3
    s_waitcnt lgkmcnt(0)
    s_cmp_gt_u32 s23, 42
    s_waitcnt vmcnt(3)
    s_cbranch_scc1 L_th_82
    s_waitcnt vmcnt(2)
L_th_82:
    buffer_load_dwordx4 v[72:75], v1, s[12:15], s33 offen nt
    v_xor_b32 v1, 67584, v1
    v_perm_b32 v32, v4, v4, v24
    v_perm_b32 v33, v4, v4, v25
    v_perm_b32 v34, v4, v4, v26
    v_perm_b32 v35, v4, v4, v27
    s_nop 1
    v_mfma_f32_16x16x32_bf16 v[20:23], v[32:35], v[144:147], 0
    v_perm_b32 v36, v4, v4, v28
    v_perm_b32 v37, v4, v4, v29
    v_perm_b32 v38, v4, v4, v30
    v_perm_b32 v39, v4, v4, v31
    s_nop 1
    v_mfma_f32_16x16x32_bf16 v[20:23], v[36:39], v[148:151], v[20:23]
    v_perm_b32 v32, v5, v5, v24
    v_perm_b32 v33, v5, v5, v25
    v_perm_b32 v34, v5, v5, v26
    v_perm_b32 v35, v5, v5, v27
    s_nop 1
    v_mfma_f32_16x16x32_bf16 v[20:23], v[32:35], v[152:155], v[20:23]
    v_perm_b32 v36, v5, v5, v28
    v_perm_b32 v37, v5, v5, v29
    v_perm_b32 v38, v5, v5, v30
    v_perm_b32 v39, v5, v5, v31
    s_nop 1
    v_mfma_f32_16x16x32_bf16 v[20:23], v[36:39], v[156:159], v[20:23]
    s_cmp_gt_u32 s23, 43
    s_waitcnt vmcnt(3)
    s_cbranch_scc1 L_th_83
    s_waitcnt vmcnt(2)
L_th_83:
    buffer_load_dwordx4 v[76:79], v1, s[12:15], s33 offen nt
    v_xor_b32 v1, 196608, v1
    v_perm_b32 v32, v6, v6, v24
    v_perm_b32 v33, v6, v6, v25
    v_perm_b32 v34, v6, v6, v26
    v_perm_b32 v35, v6, v6, v27
    s_nop 1
    v_mfma_f32_16x16x32_bf16 v[20:23], v[32:35], v[160:163], v[20:23]
    v_perm_b32 v36, v6, v6, v28
    v_perm_b32 v37, v6, v6, v29
    v_perm_b32 v38, v6, v6, v30
    v_perm_b32 v39, v6, v6, v31
    s_nop 1
    v_mfma_f32_16x16x32_bf16 v[20:23], v[36:39], v[164:167], v[20:23]
    v_perm_b32 v32, v7, v7, v24
    v_perm_b32 v33, v7, v7, v25
    v_perm_b32 v34, v7, v7, v26
    v_perm_b32 v35, v7, v7, v27
    s_nop 1
    v_mfma_f32_16x16x32_bf16 v[20:23], v[32:35], v[40:43], v[20:23]
    v_perm_b32 v36, v7, v7, v28
    v_perm_b32 v37, v7, v7, v29
    v_perm_b32 v38, v7, v7, v30
    v_perm_b32 v39, v7, v7, v31
    s_nop 1
    v_mfma_f32_16x16x32_bf16 v[20:23], v[36:39], v[44:47], v[20:23]
    s_cmp_gt_u32 s23, 44
    s_waitcnt vmcnt(3)
    s_cbranch_scc1 L_th_84
    s_waitcnt vmcnt(2)
L_th_84:
    buffer_load_dwordx4 v[80:83], v1, s[12:15], s33 offen nt
    v_xor_b32 v1, 67584, v1
    v_perm_b32 v32, v8, v8, v24
    v_perm_b32 v33, v8, v8, v25
    v_perm_b32 v34, v8, v8, v26
    v_perm_b32 v35, v8, v8, v27
    s_nop 1
    v_mfma_f32_16x16x32_bf16 v[20:23], v[32:35], v[48:51], v[20:23]
    v_perm_b32 v36, v8, v8, v28
    v_perm_b32 v37, v8, v8, v29
    v_perm_b32 v38, v8, v8, v30
    v_perm_b32 v39, v8, v8, v31
    s_nop 1
    v_mfma_f32_16x16x32_bf16 v[20:23], v[36:39], v[52:55], v[20:23]
    v_perm_b32 v32, v9, v9, v24
    v_perm_b32 v33, v9, v9, v25
    v_perm_b32 v34, v9, v9, v26
    v_perm_b32 v35, v9, v9, v27
    s_nop 1
    v_mfma_f32_16x16x32_bf16 v[20:23], v[32:35], v[56:59], v[20:23]
    v_perm_b32 v36, v9, v9, v28
    v_perm_b32 v37, v9, v9, v29
    v_perm_b32 v38, v9, v9, v30
    v_perm_b32 v39, v9, v9, v31
    s_nop 1
    v_mfma_f32_16x16x32_bf16 v[20:23], v[36:39], v[60:63], v[20:23]
    s_cmp_gt_u32 s23, 45
    s_waitcnt vmcnt(3)
    s_cbranch_scc1 L_th_85
    s_waitcnt vmcnt(2)
L_th_85:
    buffer_load_dwordx4 v[84:87], v1, s[12:15], s33 offen nt
    v_xor_b32 v1, 99328, v1
    v_perm_b32 v32, v10, v10, v24
    v_perm_b32 v33, v10, v10, v25
    v_perm_b32 v34, v10, v10, v26
    v_perm_b32 v35, v10, v10, v27
    s_nop 1
    v_mfma_f32_16x16x32_bf16 v[20:23], v[32:35], v[64:67], v[20:23]
    v_perm_b32 v36, v10, v10, v28
    v_perm_b32 v37, v10, v10, v29
    v_perm_b32 v38, v10, v10, v30
    v_perm_b32 v39, v10, v10, v31
    s_nop 1
    v_mfma_f32_16x16x32_bf16 v[20:23], v[36:39], v[68:71], v[20:23]
    s_cmp_gt_u32 s23, 46
    s_waitcnt vmcnt(3)
    s_cbranch_scc1 L_th_86
    s_waitcnt vmcnt(2)
L_th_86:
    buffer_load_dwordx4 v[88:91], v1, s[12:15], s33 offen nt
    v_xor_b32 v1, 67584, v1
    v_perm_b32 v32, v11, v11, v24
    v_perm_b32 v33, v11, v11, v25
    v_perm_b32 v34, v11, v11, v26
    v_perm_b32 v35, v11, v11, v27
    s_nop 1
    v_mfma_f32_16x16x32_bf16 v[20:23], v[32:35], v[72:75], v[20:23]
    s_cmp_gt_u32 s23, 47
    s_waitcnt vmcnt(3)
    s_cbranch_scc1 L_th_87
    s_waitcnt vmcnt(2)
L_th_87:
    buffer_load_dwordx4 v[92:95], v1, s[12:15], s33 offen nt
    v_xor_b32 v1, 34816, v1
    v_perm_b32 v36, v11, v11, v28
    v_perm_b32 v37, v11, v11, v29
    v_perm_b32 v38, v11, v11, v30
    v_perm_b32 v39, v11, v11, v31
    s_nop 1
    v_mfma_f32_16x16x32_bf16 v[20:23], v[36:39], v[76:79], v[20:23]
    s_cmp_gt_u32 s23, 48
    s_waitcnt vmcnt(3)
    s_cbranch_scc1 L_th_88
    s_waitcnt vmcnt(2)
L_th_88:
    buffer_load_dwordx4 v[96:99], v1, s[12:15], s33 offen nt
    v_xor_b32 v1, 67584, v1
    v_perm_b32 v32, v12, v12, v24
    v_perm_b32 v33, v12, v12, v25
    v_perm_b32 v34, v12, v12, v26
    v_perm_b32 v35, v12, v12, v27
    s_nop 1
    v_mfma_f32_16x16x32_bf16 v[20:23], v[32:35], v[80:83], v[20:23]
    s_cmp_gt_u32 s23, 49
    s_waitcnt vmcnt(3)
    s_cbranch_scc1 L_th_89
    s_waitcnt vmcnt(2)
L_th_89:
    buffer_load_dwordx4 v[100:103], v1, s[12:15], s33 offen nt
    v_xor_b32 v1, 99328, v1
    v_perm_b32 v36, v12, v12, v28
    v_perm_b32 v37, v12, v12, v29
    v_perm_b32 v38, v12, v12, v30
    v_perm_b32 v39, v12, v12, v31
    s_nop 1
    v_mfma_f32_16x16x32_bf16 v[20:23], v[36:39], v[84:87], v[20:23]
    s_cmp_gt_u32 s23, 50
    s_waitcnt vmcnt(8)
    s_cbranch_scc1 L_th_90
    s_waitcnt vmcnt(7)
L_th_90:
    buffer_load_dwordx4 v[104:107], v1, s[12:15], s33 offen nt
    v_xor_b32 v1, 67584, v1
    v_mov_b32 v2, 0
    ds_write_b32 v2, v24 offset:52
    s_cmp_gt_u32 s23, 51
    s_waitcnt vmcnt(8)
    s_cbranch_scc1 L_th_91
    s_waitcnt vmcnt(7)
L_th_91:
    buffer_load_dwordx4 v[108:111], v1, s[12:15], s33 offen nt
    v_xor_b32 v1, 33792, v1
    s_cmp_gt_u32 s23, 52
    s_waitcnt vmcnt(8)
    s_cbranch_scc1 L_th_92
    s_waitcnt vmcnt(7)
L_th_92:
    buffer_load_dwordx4 v[112:115], v1, s[12:15], s33 offen nt
    v_xor_b32 v1, 67584, v1
    s_cmp_gt_u32 s23, 53
    s_waitcnt vmcnt(8)
    s_cbranch_scc1 L_th_93
    s_waitcnt vmcnt(7)
L_th_93:
    buffer_load_dwordx4 v[116:119], v1, s[12:15], s33 offen nt
    v_xor_b32 v1, 99328, v1
    s_cmp_gt_u32 s23, 54
    s_waitcnt vmcnt(8)
    s_cbranch_scc1 L_th_94
    s_waitcnt vmcnt(7)
L_th_94:
    buffer_load_dwordx4 v[120:123], v1, s[12:15], s33 offen nt
    v_xor_b32 v1, 67584, v1
    s_cmp_gt_u32 s23, 55
    s_waitcnt vmcnt(8)
    s_cbranch_scc1 L_th_95
    s_waitcnt vmcnt(7)
L_th_95:
    buffer_load_dwordx4 v[124:127], v1, s[12:15], s33 offen nt
    v_xor_b32 v1, 34816, v1
    v_perm_b32 v32, v13, v13, v24
    v_perm_b32 v33, v13, v13, v25
    v_perm_b32 v34, v13, v13, v26
    v_perm_b32 v35, v13, v13, v27
    s_nop 1
    v_mfma_f32_16x16x32_bf16 v[20:23], v[32:35], v[88:91], v[20:23]
    s_cmp_gt_u32 s23, 56
    s_waitcnt vmcnt(8)
    s_cbranch_scc1 L_th_96
    s_waitcnt vmcnt(7)
L_th_96:
    buffer_load_dwordx4 v[128:131], v1, s[12:15], s33 offen nt
    v_xor_b32 v1, 67584, v1
    v_perm_b32 v36, v13, v13, v28
    v_perm_b32 v37, v13, v13, v29
    v_perm_b32 v38, v13, v13, v30
    v_perm_b32 v39, v13, v13, v31
    s_nop 1
    v_mfma_f32_16x16x32_bf16 v[20:23], v[36:39], v[92:95], v[20:23]
    s_cmp_gt_u32 s23, 57
    s_waitcnt vmcnt(8)
    s_cbranch_scc1 L_th_97
    s_waitcnt vmcnt(7)
L_th_97:
    buffer_load_dwordx4 v[132:135], v1, s[12:15], s33 offen nt
    v_xor_b32 v1, 99328, v1
    v_perm_b32 v32, v14, v14, v24
    v_perm_b32 v33, v14, v14, v25
    v_perm_b32 v34, v14, v14, v26
    v_perm_b32 v35, v14, v14, v27
    s_nop 1
    v_mfma_f32_16x16x32_bf16 v[20:23], v[32:35], v[96:99], v[20:23]
    s_cmp_gt_u32 s23, 58
    s_waitcnt vmcnt(8)
    s_cbranch_scc1 L_th_98
    s_waitcnt vmcnt(7)
L_th_98:
    buffer_load_dwordx4 v[136:139], v1, s[12:15], s33 offen nt
    v_xor_b32 v1, 67584, v1
    v_perm_b32 v36, v14, v14, v28
    v_perm_b32 v37, v14, v14, v29
    v_perm_b32 v38, v14, v14, v30
    v_perm_b32 v39, v14, v14, v31
    s_nop 1
    v_mfma_f32_16x16x32_bf16 v[20:23], v[36:39], v[100:103], v[20:23]
    s_cmp_gt_u32 s23, 59
    s_waitcnt vmcnt(8)
    s_cbranch_scc1 L_th_99
    s_waitcnt vmcnt(7)
L_th_99:
    buffer_load_dwordx4 v[140:143], v1, s[12:15], s33 offen nt
    v_lshlrev_b32 v1, 4, v0
    v_perm_b32 v32, v15, v15, v24
    v_perm_b32 v33, v15, v15, v25
    v_perm_b32 v34, v15, v15, v26
    v_perm_b32 v35, v15, v15, v27
    s_nop 1
    v_mfma_f32_16x16x32_bf16 v[20:23], v[32:35], v[104:107], v[20:23]
    v_mov_b32 v2, 0
    v_mov_b32 v4, 1
    s_mov_b64 exec, 1
    ds_add_u32 v2, v4 offset:20
    s_mov_b64 exec, -1
    s_mov_b32 s7, 0
L_lw_100:
    ds_read_b32 v4, v2 offset:48
    s_waitcnt lgkmcnt(0)
    v_readfirstlane_b32 s28, v4
    s_nop 0
    s_cmp_ge_u32 s28, 1
    s_cbranch_scc1 L_lwd_101
    s_sleep 1
    s_add_u32 s7, s7, 1
    s_cmp_lt_u32 s7, 1048576
    s_cbranch_scc1 L_lw_100
L_lwd_101:
    s_mov_b32 s6, s28
    s_lshl_b32 s28, s3, 2
    v_and_b32 v4, 32, v0
    v_add_u32 v4, s28, v4
    ds_read_b32 v5, v4 offset:64
    v_and_b32 v6, 3, v0
    v_mul_u32_u24 v6, 7, v6
    v_bfe_u32 v6, s35, v6, 12
    v_mov_b32 v4, 1
    s_lshl_b32 s29, s4, 5
    s_add_u32 s29, s29, s5
    s_lshl_b32 s29, s29, 10
    v_perm_b32 v36, v15, v15, v28
    v_perm_b32 v37, v15, v15, v29
    v_perm_b32 v38, v15, v15, v30
    v_perm_b32 v39, v15, v15, v31
    s_waitcnt vmcnt(8)
    s_nop 0
    v_mfma_f32_16x16x32_bf16 v[20:23], v[36:39], v[108:111], v[20:23]
    v_perm_b32 v32, v16, v16, v24
    v_perm_b32 v33, v16, v16, v25
    v_perm_b32 v34, v16, v16, v26
    v_perm_b32 v35, v16, v16, v27
    s_waitcnt vmcnt(7)
    s_nop 0
    v_mfma_f32_16x16x32_bf16 v[20:23], v[32:35], v[112:115], v[20:23]
    v_perm_b32 v36, v16, v16, v28
    v_perm_b32 v37, v16, v16, v29
    v_perm_b32 v38, v16, v16, v30
    v_perm_b32 v39, v16, v16, v31
    s_waitcnt vmcnt(6)
    s_nop 0
    v_mfma_f32_16x16x32_bf16 v[20:23], v[36:39], v[116:119], v[20:23]
    v_perm_b32 v32, v17, v17, v24
    v_perm_b32 v33, v17, v17, v25
    v_perm_b32 v34, v17, v17, v26
    v_perm_b32 v35, v17, v17, v27
    s_waitcnt vmcnt(5)
    s_nop 0
    v_mfma_f32_16x16x32_bf16 v[20:23], v[32:35], v[120:123], v[20:23]
    v_perm_b32 v36, v17, v17, v28
    v_perm_b32 v37, v17, v17, v29
    v_perm_b32 v38, v17, v17, v30
    v_perm_b32 v39, v17, v17, v31
    s_waitcnt vmcnt(4)
    s_nop 0
    v_mfma_f32_16x16x32_bf16 v[20:23], v[36:39], v[124:127], v[20:23]
    v_perm_b32 v32, v18, v18, v24
    v_perm_b32 v33, v18, v18, v25
    v_perm_b32 v34, v18, v18, v26
    v_perm_b32 v35, v18, v18, v27
    s_waitcnt vmcnt(3)
    s_nop 0
    v_mfma_f32_16x16x32_bf16 v[20:23], v[32:35], v[128:131], v[20:23]
    v_perm_b32 v36, v18, v18, v28
    v_perm_b32 v37, v18, v18, v29
    v_perm_b32 v38, v18, v18, v30
    v_perm_b32 v39, v18, v18, v31
    s_waitcnt vmcnt(2)
    s_nop 0
    v_mfma_f32_16x16x32_bf16 v[20:23], v[36:39], v[132:135], v[20:23]
    v_perm_b32 v32, v19, v19, v24
    v_perm_b32 v33, v19, v19, v25
    v_perm_b32 v34, v19, v19, v26
    v_perm_b32 v35, v19, v19, v27
    s_waitcnt vmcnt(1)
    s_nop 0
    v_mfma_f32_16x16x32_bf16 v[20:23], v[32:35], v[136:139], v[20:23]
    v_perm_b32 v36, v19, v19, v28
    v_perm_b32 v37, v19, v19, v29
    v_perm_b32 v38, v19, v19, v30
    v_perm_b32 v39, v19, v19, v31
    s_waitcnt vmcnt(0)
    s_nop 0
    v_mfma_f32_16x16x32_bf16 v[20:23], v[36:39], v[140:143], v[20:23]
    s_waitcnt lgkmcnt(0)
    s_nop 6
    v_mul_f32 v20, v5, v20
    v_mul_f32 v21, v5, v21
    v_mul_f32 v22, v5, v22
    v_mul_f32 v23, v5, v23
    ds_write_b128 v3, v[20:23] offset:8192
    s_mov_b64 exec, 1
    ds_add_rtn_u32 v4, v2, v4 offset:44
    s_mov_b64 exec, -1
    ds_read_b128 v[40:43], v1 offset:8192
    ds_read_b128 v[44:47], v1 offset:9216
    ds_read_b128 v[48:51], v1 offset:10240
    ds_read_b128 v[52:55], v1 offset:11264
    ds_read_b128 v[56:59], v1 offset:12288
    ds_read_b128 v[60:63], v1 offset:13312
    ds_read_b128 v[64:67], v1 offset:14336
    ds_read_b128 v[68:71], v1 offset:15360
    s_waitcnt lgkmcnt(8)
    v_readfirstlane_b32 s28, v4
    s_nop 0
    s_cmp_lg_u32 s28, 7
    s_cbranch_scc1 L_noreduce
L_reduce:
    s_waitcnt lgkmcnt(6)
    v_pk_add_f32 v[40:41], v[40:41], v[44:45]
    v_pk_add_f32 v[42:43], v[42:43], v[46:47]
    s_waitcnt lgkmcnt(4)
    v_pk_add_f32 v[48:49], v[48:49], v[52:53]
    v_pk_add_f32 v[50:51], v[50:51], v[54:55]
    v_pk_add_f32 v[40:41], v[40:41], v[48:49]
    v_pk_add_f32 v[42:43], v[42:43], v[50:51]
    s_waitcnt lgkmcnt(2)
    v_pk_add_f32 v[56:57], v[56:57], v[60:61]
    v_pk_add_f32 v[58:59], v[58:59], v[62:63]
    v_pk_add_f32 v[40:41], v[40:41], v[56:57]
    v_pk_add_f32 v[42:43], v[42:43], v[58:59]
    s_waitcnt lgkmcnt(0)
    v_pk_add_f32 v[64:65], v[64:65], v[68:69]
    v_pk_add_f32 v[66:67], v[66:67], v[70:71]
    v_pk_add_f32 v[40:41], v[40:41], v[64:65]
    v_pk_add_f32 v[42:43], v[42:43], v[66:67]
    v_and_or_b32 v40, v40, s90, v6
    s_cmp_eq_u32 s6, 3
    s_cbranch_scc0 L_is_102
    buffer_store_dwordx4 v[40:43], v1, s[24:27], s29 offen
L_isd_103:
    v_mov_b32 v4, 9
    ds_write_b32 v2, v4 offset:44
L_noreduce:
    s_cmp_ge_u32 s5, 9
    s_cbranch_scc1 L_nogather
    s_lshl_b32 s16, s4, 3
    s_add_u32 s16, s16, s3
    s_lshl_b32 s16, s16, 12
    s_lshr_b32 s28, s3, 1
    s_lshl_b32 s28, s28, 6
    s_and_b32 s29, s3, 1
    s_lshl_b32 s30, s29, 4
    s_add_u32 s28, s28, s30
    v_and_b32 v3, 32, v0
    v_add_u32 v3, s28, v3
    s_lshl_b32 s29, s29, 1
    s_lshr_b32 s30, s3, 2
    s_add_u32 s29, s29, s30
    s_mul_i32 s29, s29, 1088
    s_bfe_u32 s30, s3, 0x10001
    s_lshl_b32 s30, s30, 9
    s_add_u32 s29, s29, s30
    v_lshlrev_b32 v7, 3, v0
    v_add_u32 v7, s29, v7
    s_cbranch_execz L_ggo
    s_mov_b32 s7, 0
L_lw_104:
    ds_read_b32 v4, v2 offset:56
    s_waitcnt lgkmcnt(0)
    v_readfirstlane_b32 s28, v4
    s_nop 0
    s_cmp_ge_u32 s28, 4
    s_cbranch_scc1 L_lwd_105
    s_sleep 1
    s_add_u32 s7, s7, 1
    s_cmp_lt_u32 s7, 1048576
    s_cbranch_scc1 L_lw_104
L_lwd_105:
    ds_read_b128 v[8:11], v3 offset:768
    s_mov_b32 s7, 0
L_lw_106:
    ds_read_b32 v4, v2 offset:44
    s_waitcnt lgkmcnt(0)
    v_readfirstlane_b32 s28, v4
    s_nop 0
    s_cmp_ge_u32 s28, 9
    s_cbranch_scc1 L_lwd_107
    s_sleep 1
    s_add_u32 s7, s7, 1
    s_cmp_lt_u32 s7, 1048576
    s_cbranch_scc1 L_lw_106
L_lwd_107:
L_ggo:
    s_mov_b32 s7, 0
    buffer_load_dwordx4 v[72:75], v1, s[24:27], s16 offen offset:0 sc1
    buffer_load_dwordx4 v[76:79], v1, s[24:27], s16 offen offset:1024 sc1
    buffer_load_dwordx4 v[80:83], v1, s[24:27], s16 offen offset:2048 sc1
    buffer_load_dwordx4 v[84:87], v1, s[24:27], s16 offen offset:3072 sc1
L_opl:
    s_waitcnt vmcnt(3)
    v_xor_b32 v72, v6, v72
    v_mul_f32 v13, v8, v73
    v_mul_f32 v14, v8, v74
    v_mul_f32 v15, v8, v75
    v_mul_f32 v12, v8, v72
    s_waitcnt vmcnt(2)
    v_xor_b32 v76, v6, v76
    v_fmac_f32 v13, v9, v77
    v_fmac_f32 v14, v9, v78
    v_fmac_f32 v15, v9, v79
    v_fmac_f32 v12, v9, v76
    s_waitcnt vmcnt(1)
    v_xor_b32 v80, v6, v80
    v_fmac_f32 v13, v10, v81
    v_fmac_f32 v14, v10, v82
    v_fmac_f32 v15, v10, v83
    v_fmac_f32 v12, v10, v80
    v_or3_b32 v16, v72, v76, v80
    s_waitcnt vmcnt(0)
    v_xor_b32 v84, v6, v84
    v_fmac_f32 v13, v11, v85
    v_fmac_f32 v14, v11, v86
    v_fmac_f32 v15, v11, v87
    v_fmac_f32 v12, v11, v84
    v_cvt_pk_bf16_f32 v12, v12, v13
    v_cvt_pk_bf16_f32 v13, v14, v15
    ds_write_b64 v7, v[12:13] offset:1216
    v_or_b32 v16, v16, v84
    v_and_b32 v16, 0xfff, v16
    v_cmp_ne_u32 vcc, 0, v16
    s_nop 0
    s_cbranch_vccz L_ook
    buffer_load_dwordx4 v[72:75], v1, s[24:27], s16 offen offset:0 sc1
    buffer_load_dwordx4 v[76:79], v1, s[24:27], s16 offen offset:1024 sc1
    buffer_load_dwordx4 v[80:83], v1, s[24:27], s16 offen offset:2048 sc1
    buffer_load_dwordx4 v[84:87], v1, s[24:27], s16 offen offset:3072 sc1
    s_add_u32 s7, s7, 1
    s_cmp_lt_u32 s7, 131072
    s_cbranch_scc1 L_opl
L_ook:
    s_branch L_slast
L_nogather:
    s_sub_u32 s28, s5, 15
    s_cmp_lt_u32 s28, 4
    s_cselect_b32 s28, s28, 9
    s_sub_u32 s7, s5, 23
    s_cmp_ge_u32 s5, 27
    s_cselect_b32 s28, s7, s28
    s_cmp_ge_u32 s28, 9
    s_cbranch_scc1 L_sdone
    s_cmp_ge_u32 s3, 5
    s_cbranch_scc1 L_sdone
    s_lshl_b32 s28, s3, 6
    v_add_u32 v2, s28, v0
    v_min_u32 v2, 287, v2
    v_and_b32 v22, 3, v2
    v_mul_u32_u24 v22, 7, v22
    v_bfe_u32 v22, s35, v22, 12
    v_lshlrev_b32 v1, 4, v2
    v_lshlrev_b32 v2, 2, v2
    s_mul_i32 s18, s4, 9216
    s_add_u32 s18, s18, 262144
    s_add_u32 s19, s18, 4608
    v_mov_b32 v8, 3216550459
    v_mov_b32 v9, v8
    v_mov_b32 v10, 1.0
    v_mov_b32 v11, 1.0
    v_mov_b32 v3, 0
    s_cbranch_execz L_hgo
    s_waitcnt lgkmcnt(0)
    s_barrier
    s_barrier
    s_cmp_ge_u32 s5, 27
    s_cbranch_scc1 L_hgo
    buffer_load_dwordx4 v[40:43], v1, s[24:27], s18 offen sc1
    buffer_load_dwordx4 v[44:47], v1, s[24:27], s19 offen sc1
    s_barrier
    s_barrier
    s_waitcnt vmcnt(0)
L_hgo:
    s_mov_b32 s7, 0
    buffer_load_dwordx4 v[40:43], v1, s[24:27], s18 offen sc1
    buffer_load_dwordx4 v[44:47], v1, s[24:27], s19 offen sc1
L_pp_108:
    s_waitcnt vmcnt(0)
    v_xor_b32 v40, v22, v40
    v_xor_b32 v42, v22, v42
    v_xor_b32 v44, v22, v44
    v_xor_b32 v46, v22, v46
    v_or3_b32 v20, v40, v42, v44
    v_or_b32 v20, v20, v46
    v_and_b32 v20, 0xfff, v20
    v_cmp_ne_u32 vcc, 0, v20
    s_nop 0
    s_cbranch_vccz L_ppk_110
    buffer_load_dwordx4 v[40:43], v1, s[24:27], s18 offen sc1
    buffer_load_dwordx4 v[44:47], v1, s[24:27], s19 offen sc1
    s_add_u32 s7, s7, 1
    s_cmp_lt_u32 s7, 131072
    s_cbranch_scc1 L_pp_108
    s_waitcnt vmcnt(0)
L_ppk_110:
    v_pk_mul_f32 v[4:5], v[40:41], v[8:9]
    v_pk_mul_f32 v[6:7], v[42:43], v[8:9]
    v_pk_mul_f32 v[16:17], v[44:45], v[40:41]
    v_pk_mul_f32 v[18:19], v[46:47], v[42:43]
L_ppd_109:
    v_exp_f32 v4, v4
    v_exp_f32 v5, v5
    v_exp_f32 v6, v6
    v_exp_f32 v7, v7
    v_pk_add_f32 v[4:5], v[4:5], v[10:11]
    v_pk_add_f32 v[6:7], v[6:7], v[10:11]
    v_rcp_f32 v4, v4
    v_rcp_f32 v5, v5
    v_rcp_f32 v6, v6
    v_rcp_f32 v7, v7
    v_pk_mul_f32 v[16:17], v[16:17], v[4:5]
    v_pk_mul_f32 v[18:19], v[18:19], v[6:7]
    v_cvt_pk_bf16_f32 v12, v16, v18
    v_cvt_pk_bf16_f32 v13, v17, v19
    ds_write_b32 v2, v12 offset:15104
    ds_write_b32 v2, v13 offset:64
L_slast:
    s_waitcnt lgkmcnt(0)
    s_cbranch_execz L_ret_s
    s_barrier
L_sdone:
    s_cbranch_execz L_ret_s
    s_endpgm
L_tailprep:
    s_mov_b64 s[88:89], -1
    s_cmp_lg_u32 s3, 2
    s_cbranch_scc1 L_tp2
    s_mov_b32 s6, 3
    s_mov_b32 s29, 0
    v_mov_b32 v2, 0
    s_mov_b64 s[88:89], 0
    s_mov_b64 exec, 0
    s_branch L_reduce
L_ret_s:
    s_mov_b64 s[88:89], -1
    s_mov_b64 exec, -1
L_tp2:
    s_cmp_ge_u32 s5, 27
    s_cbranch_scc1 L_w2late
    s_cmp_lt_u32 s5, 9
    s_cbranch_scc1 L_owner
    s_cmp_lg_u32 s3, 1
    s_cbranch_scc1 L_now_w
    v_bfe_u32 v4, v0, 2, 2
    v_lshrrev_b32 v5, 4, v0
    v_lshl_add_u32 v4, v5, 3, v4
    v_lshlrev_b32 v4, 7, v4
    v_and_b32 v6, 3, v0
    v_lshl_add_u32 v4, v6, 3, v4
    v_bfe_u32 v7, v0, 3, 2
    v_xor_b32 v7, s3, v7
    v_lshl_add_u32 v2, v7, 5, v4
    v_and_b32 v3, 1, v0
    v_mul_u32_u24 v3, 1152, v3
    v_lshl_add_u32 v3, v5, 4, v3
    v_mov_b32 v8, 5888
    v_mov_b32 v9, 1216
    v_mov_b32 v10, 3552
    v_cmp_eq_u32 vcc, 1, v6
    s_nop 1
    v_cndmask_b32 v4, v8, v9, vcc
    v_cmp_eq_u32 vcc, 2, v6
    s_nop 1
    v_cndmask_b32 v4, v4, v10, vcc
    v_bfe_u32 v7, v0, 2, 1
    v_mul_u32_u24 v7, 1152, v7
    v_lshl_add_u32 v7, v5, 4, v7
    v_add_u32 v4, v4, v7
    v_and_b32 v3, 1, v0
    v_xor_b32 v3, 1, v3
    v_mul_u32_u24 v3, 15040, v3
    v_lshl_add_u32 v3, v5, 4, v3
    s_sub_u32 s30, s5, 9
    s_lshr_b32 s30, s30, 1
    s_sub_u32 s7, 3, s4
    s_and_b32 s7, s7, 7
    s_add_u32 s30, s30, s7
    s_cmp_ge_u32 s30, 9
    s_cselect_b32 s7, 9, 0
    s_sub_u32 s30, s30, s7
    s_bitcmp0_b32 s5, 0
    s_cselect_b32 s29, 9, 0
    s_add_u32 s30, s30, s29
    s_lshl_b32 s30, s30, 2
    s_add_u32 s30, s30, s3
    s_lshl_b32 s64, s30, 7
    s_mul_i32 s29, s4, 9216
    s_add_u32 s64, s64, s29
    s_add_u32 s64, s64, 262144
    s_mul_i32 s65, s4, 3072
    s_add_u32 s65, s65, 409600
    s_sub_u32 s30, s5, 15
    s_cmp_lt_u32 s30, 4
    s_cselect_b32 s30, s30, 9
    s_sub_u32 s7, s5, 23
    s_cmp_ge_u32 s5, 27
    s_cselect_b32 s30, s7, s30
    s_lshl_b32 s30, s30, 2
    s_add_u32 s30, s30, s3
    s_lshl_b32 s30, s30, 7
    s_lshl_b32 s66, s4, 14
    s_add_u32 s66, s66, s30
    s_add_u32 s66, s66, 655360
    s_add_u32 s70, s66, 8192
    s_mul_i32 s28, s3, 45
    v_min_u32 v12, 44, v0
    v_add_u32 v12, s28, v12
    v_lshlrev_b32 v12, 4, v12
    v_and_b32 v8, 15, v0
    v_lshrrev_b32 v9, 5, v0
    v_lshl_add_u32 v9, v9, 4, v8
    v_cmp_gt_u32 vcc, 18, v9
    v_bfe_u32 v10, v0, 4, 1
    v_mul_u32_u24 v11, 288, v10
    v_lshl_add_u32 v16, v9, 4, v11
    v_add_u32 v16, 8192, v16
    v_mov_b32 v9, 5856
    v_cndmask_b32 v16, v9, v16, vcc
    v_and_b32 v8, 3, v0
    v_lshlrev_b32 v8, 2, v8
    ds_write_b32 v8, v1 offset:5856
    v_lshlrev_b32 v7, 3, v0
    s_mov_b32 s68, 0x3ae38e39
    s_mov_b32 s69, 0x3727c5ac
    s_mov_b32 s6, 3
    s_mov_b64 s[88:89], 0
    s_mov_b64 exec, 0
    s_branch L_wt
L_ret_w:
    s_mov_b64 s[88:89], -1
    s_mov_b64 exec, -1
L_now_w:
    s_mov_b32 s7, 0
L_lw_111:
    ds_read_b32 v8, v1 offset:4
    s_waitcnt lgkmcnt(0)
    v_readfirstlane_b32 s28, v8
    s_nop 0
    s_cmp_ge_u32 s28, 1
    s_cbranch_scc1 L_lwd_112
    s_sleep 8
    s_add_u32 s7, s7, 1
    s_cmp_lt_u32 s7, 1048576
    s_cbranch_scc1 L_lw_111
L_lwd_112:
    s_waitcnt lgkmcnt(0)
    s_mul_i32 s35, s34, 0x9E3779B1
    s_add_u32 s35, s35, 0x7F4A7C15
    s_mov_b32 s90, 0xfffff000
    v_and_b32 v8, 31, v0
    v_min_u32 v9, 7, v8
    s_mul_i32 s28, s3, 72
    v_add_u32 v8, s28, v8
    s_add_u32 s28, s28, 64
    v_add_u32 v9, s28, v9
    v_lshrrev_b32 v11, 5, v0
    v_mul_u32_u24 v11, 1152, v11
    v_lshl_add_u32 v10, v8, 2, v11
    v_lshl_add_u32 v11, v9, 2, v11
    s_mov_b32 s30, 865792
    s_mov_b32 s31, 870400
    v_lshlrev_b32 v12, 4, v8
    v_lshlrev_b32 v13, 4, v9
    s_mov_b32 s7, 0
L_pl_113:
    buffer_load_dwordx4 v[36:39], v12, s[24:27], s30 offen sc1
    buffer_load_dwordx4 v[40:43], v12, s[24:27], s30 offen offset:512 sc1
    buffer_load_dwordx4 v[44:47], v13, s[24:27], s30 offen sc1
    buffer_load_dwordx4 v[48:51], v12, s[24:27], s31 offen sc1
    buffer_load_dwordx4 v[52:55], v12, s[24:27], s31 offen offset:512 sc1
    buffer_load_dwordx4 v[56:59], v13, s[24:27], s31 offen sc1
    s_waitcnt vmcnt(0)
    v_xor_b32 v14, s35, v37
    v_bitop3_b32 v14, v14, v39, s35 bitop3:0xf6
    v_bitop3_b32 v14, v14, v41, s35 bitop3:0xf6
    v_bitop3_b32 v14, v14, v43, s35 bitop3:0xf6
    v_bitop3_b32 v14, v14, v45, s35 bitop3:0xf6
    v_bitop3_b32 v14, v14, v47, s35 bitop3:0xf6
    v_bitop3_b32 v14, v14, v49, s35 bitop3:0xf6
    v_bitop3_b32 v14, v14, v51, s35 bitop3:0xf6
    v_bitop3_b32 v14, v14, v53, s35 bitop3:0xf6
    v_bitop3_b32 v14, v14, v55, s35 bitop3:0xf6
    v_bitop3_b32 v14, v14, v57, s35 bitop3:0xf6
    v_bitop3_b32 v14, v14, v59, s35 bitop3:0xf6
    v_cmp_ne_u32 vcc, 0, v14
    s_nop 0
    s_cbranch_vccz L_pld_114
    s_sleep 2
    s_add_u32 s7, s7, 1
    s_cmp_lt_u32 s7, 131072
    s_cbranch_scc1 L_pl_113
L_pld_114:
    v_cmp_gt_u32 vcc, 32, v0
    v_mov_b32 v12, 0x03020c0c
    v_mov_b32 v13, 0x01000c0c
    v_cndmask_b32 v12, v12, v13, vcc
    v_perm_b32 v24, v36, v36, v12
    v_perm_b32 v25, v38, v38, v12
    v_perm_b32 v26, v40, v40, v12
    v_perm_b32 v27, v42, v42, v12
    v_perm_b32 v28, v44, v44, v12
    v_perm_b32 v29, v46, v46, v12
    v_perm_b32 v30, v48, v48, v12
    v_perm_b32 v31, v50, v50, v12
    v_perm_b32 v32, v52, v52, v12
    v_perm_b32 v33, v54, v54, v12
    v_perm_b32 v34, v56, v56, v12
    v_perm_b32 v35, v58, v58, v12
    v_add_f32 v30, 1.0, v30
    v_add_f32 v31, 1.0, v31
    v_cvt_pk_bf16_f32 v12, v30, v31
    v_cvt_pk_bf16_f32 v13, v24, v25
    ds_write_b32 v10, v12 offset:1216
    ds_write_b32 v10, v13 offset:3552
    v_add_f32 v32, 1.0, v32
    v_add_f32 v33, 1.0, v33
    v_cvt_pk_bf16_f32 v12, v32, v33
    v_cvt_pk_bf16_f32 v13, v26, v27
    ds_write_b32 v10, v12 offset:1344
    ds_write_b32 v10, v13 offset:3680
    v_add_f32 v34, 1.0, v34
    v_add_f32 v35, 1.0, v35
    v_cvt_pk_bf16_f32 v12, v34, v35
    v_cvt_pk_bf16_f32 v13, v28, v29
    ds_write_b32 v11, v12 offset:1216
    ds_write_b32 v11, v13 offset:3552
    s_mov_b32 s7, 0
L_lw_115:
    ds_read_b32 v8, v1 offset:0
    s_waitcnt lgkmcnt(0)
    v_readfirstlane_b32 s28, v8
    s_nop 0
    s_cmp_ge_u32 s28, 1
    s_cbranch_scc1 L_lwd_116
    s_sleep 4
    s_add_u32 s7, s7, 1
    s_cmp_lt_u32 s7, 1048576
    s_cbranch_scc1 L_lw_115
L_lwd_116:
    s_mov_b32 s6, s28
    v_bfe_u32 v4, v0, 2, 2
    v_lshrrev_b32 v5, 4, v0
    v_lshl_add_u32 v4, v5, 3, v4
    v_lshlrev_b32 v4, 7, v4
    v_and_b32 v6, 3, v0
    v_lshl_add_u32 v4, v6, 3, v4
    v_bfe_u32 v7, v0, 3, 2
    v_xor_b32 v7, s3, v7
    v_lshl_add_u32 v2, v7, 5, v4
    v_and_b32 v3, 1, v0
    v_mul_u32_u24 v3, 1152, v3
    v_lshl_add_u32 v3, v5, 4, v3
    v_mov_b32 v8, 5888
    v_mov_b32 v9, 1216
    v_mov_b32 v10, 3552
    v_cmp_eq_u32 vcc, 1, v6
    s_nop 1
    v_cndmask_b32 v4, v8, v9, vcc
    v_cmp_eq_u32 vcc, 2, v6
    s_nop 1
    v_cndmask_b32 v4, v4, v10, vcc
    v_bfe_u32 v7, v0, 2, 1
    v_mul_u32_u24 v7, 1152, v7
    v_lshl_add_u32 v7, v5, 4, v7
    v_add_u32 v4, v4, v7
    v_and_b32 v3, 1, v0
    v_xor_b32 v3, 1, v3
    v_mul_u32_u24 v3, 15040, v3
    v_lshl_add_u32 v3, v5, 4, v3
    s_sub_u32 s30, s5, 9
    s_lshr_b32 s30, s30, 1
    s_sub_u32 s7, 3, s4
    s_and_b32 s7, s7, 7
    s_add_u32 s30, s30, s7
    s_cmp_ge_u32 s30, 9
    s_cselect_b32 s7, 9, 0
    s_sub_u32 s30, s30, s7
    s_bitcmp0_b32 s5, 0
    s_cselect_b32 s29, 9, 0
    s_add_u32 s30, s30, s29
    s_lshl_b32 s30, s30, 2
    s_add_u32 s30, s30, s3
    s_lshl_b32 s64, s30, 7
    s_mul_i32 s29, s4, 9216
    s_add_u32 s64, s64, s29
    s_add_u32 s64, s64, 262144
    s_mul_i32 s65, s4, 3072
    s_add_u32 s65, s65, 409600
    s_sub_u32 s30, s5, 15
    s_cmp_lt_u32 s30, 4
    s_cselect_b32 s30, s30, 9
    s_sub_u32 s7, s5, 23
    s_cmp_ge_u32 s5, 27
    s_cselect_b32 s30, s7, s30
    s_lshl_b32 s30, s30, 2
    s_add_u32 s30, s30, s3
    s_lshl_b32 s30, s30, 7
    s_lshl_b32 s66, s4, 14
    s_add_u32 s66, s66, s30
    s_add_u32 s66, s66, 655360
    s_add_u32 s70, s66, 8192
    s_mul_i32 s28, s3, 45
    v_min_u32 v12, 44, v0
    v_add_u32 v12, s28, v12
    v_lshlrev_b32 v12, 4, v12
    v_and_b32 v8, 15, v0
    v_lshrrev_b32 v9, 5, v0
    v_lshl_add_u32 v9, v9, 4, v8
    v_cmp_gt_u32 vcc, 18, v9
    v_bfe_u32 v10, v0, 4, 1
    v_mul_u32_u24 v11, 288, v10
    v_lshl_add_u32 v16, v9, 4, v11
    v_add_u32 v16, 8192, v16
    v_mov_b32 v9, 5856
    v_cndmask_b32 v16, v9, v16, vcc
    v_and_b32 v8, 3, v0
    v_lshlrev_b32 v8, 2, v8
    ds_write_b32 v8, v1 offset:5856
    v_lshlrev_b32 v7, 3, v0
    s_mov_b32 s68, 0x3ae38e39
    s_mov_b32 s69, 0x3727c5ac
    s_mov_b32 s20, 9216
    v_lshrrev_b32 v26, 3, v0
    v_mul_lo_u32 v26, v26, s20
    v_and_b32 v24, 7, v0
    v_bfe_u32 v25, v0, 4, 1
    v_lshlrev_b32 v25, 1, v25
    v_xor_b32 v24, v24, v25
    v_xor_b32 v25, 4, v24
    v_lshl_add_u32 v24, v24, 4, v26
    v_lshl_add_u32 v25, v25, 4, v26
    s_lshl_b32 s17, s20, 3
    s_sub_u32 s28, s5, 9
    s_lshr_b32 s28, s28, 1
    s_sub_u32 s7, 3, s4
    s_and_b32 s7, s7, 7
    s_add_u32 s28, s28, s7
    s_cmp_ge_u32 s28, 9
    s_cselect_b32 s7, 9, 0
    s_sub_u32 s28, s28, s7
    s_bitcmp0_b32 s5, 0
    s_cselect_b32 s8, s50, s48
    s_cselect_b32 s9, s51, s49
    s_mov_b32 s10, 5308416
    s_mov_b32 s11, 0x20000
    s_mul_i32 s16, s4, 1152
    s_lshl_b32 s28, s28, 7
    s_add_u32 s16, s16, s28
    s_mul_i32 s28, s3, 73728
    s_add_u32 s16, s16, s28
    s_mov_b32 s17, 294912
    s_lshl_b32 s29, s3, 10
    s_add_u32 s29, s29, 16384
    s_mov_b32 s19, 9
    s_bitcmp1_b32 s3, 0
    s_cselect_b64 vcc, -1, 0
    v_cndmask_b32 v24, v24, v25, vcc
    v_lshrrev_b32 v5, 1, v0
    v_and_b32 v5, 3, v5
    v_mul_u32_u24 v5, 7, v5
    v_bfe_u32 v5, s35, v5, 12
    s_bfe_u32 s30, s16, 0x30007
    s_cmp_eq_u32 s30, 3
    s_cselect_b32 s19, 2, 0
    s_cmp_lt_u32 s5, 11
    s_cselect_b32 s19, 0, s19
    s_sub_u32 s31, 9, s19
    s_cmp_eq_u32 s19, 0
    s_cbranch_scc1 L_nol1
    s_mov_b32 s7, 0
L_lw_117:
    ds_read_b32 v8, v1 offset:8
    s_waitcnt lgkmcnt(0)
    v_readfirstlane_b32 s28, v8
    s_nop 0
    s_cmp_ge_u32 s28, 8
    s_cbranch_scc1 L_lwd_118
    s_sleep 4
    s_add_u32 s7, s7, 1
    s_cmp_lt_u32 s7, 1048576
    s_cbranch_scc1 L_lw_117
L_lwd_118:
L_dma_l1:
    s_mov_b32 m0, s29
    s_add_u32 s29, s29, 4096
    buffer_load_dwordx4 v24, s[8:11], s16 offen nt lds
    s_add_u32 s16, s16, s17
    s_waitcnt vmcnt(1)
    s_mov_b32 m0, s29
    s_add_u32 s29, s29, 4096
    buffer_load_dwordx4 v24, s[8:11], s16 offen nt lds
    s_add_u32 s16, s16, s17
    s_waitcnt vmcnt(1)
    s_sub_u32 s19, s19, 1
    s_cmp_lg_u32 s19, 0
    s_cbranch_scc1 L_dma_l1
L_nol1:
    s_mov_b32 s19, s31
    s_mov_b32 s7, 0
L_lw_119:
    ds_read_b32 v8, v1 offset:20
    s_waitcnt lgkmcnt(0)
    v_readfirstlane_b32 s28, v8
    s_nop 0
    s_cmp_ge_u32 s28, 8
    s_cbranch_scc1 L_lwd_120
    s_sleep 1
    s_add_u32 s7, s7, 1
    s_cmp_lt_u32 s7, 1048576
    s_cbranch_scc1 L_lw_119
L_lwd_120:
    s_sub_u32 s31, s19, 2
    s_mov_b32 s19, 2
L_dma_l3:
    s_mov_b32 m0, s29
    s_add_u32 s29, s29, 4096
    buffer_load_dwordx4 v24, s[8:11], s16 offen nt lds
    s_add_u32 s16, s16, s17
    s_mov_b32 m0, s29
    s_add_u32 s29, s29, 4096
    buffer_load_dwordx4 v24, s[8:11], s16 offen nt lds
    s_add_u32 s16, s16, s17
    s_sub_u32 s19, s19, 1
    s_cmp_lg_u32 s19, 0
    s_cbranch_scc1 L_dma_l3
    s_mov_b32 s19, s31
    s_mov_b32 s7, 0
L_lw_121:
    ds_read_b32 v8, v1 offset:44
    s_waitcnt lgkmcnt(0)
    v_readfirstlane_b32 s28, v8
    s_nop 0
    s_cmp_ge_u32 s28, 9
    s_cbranch_scc1 L_lwd_122
    s_sleep 1
    s_add_u32 s7, s7, 1
    s_cmp_lt_u32 s7, 1048576
    s_cbranch_scc1 L_lw_121
L_lwd_122:
    s_setprio 3
L_dma_late:
    s_mov_b32 m0, s29
    s_add_u32 s29, s29, 4096
    buffer_load_dwordx4 v24, s[8:11], s16 offen nt lds
    s_add_u32 s16, s16, s17
    s_mov_b32 m0, s29
    s_add_u32 s29, s29, 4096
    buffer_load_dwordx4 v24, s[8:11], s16 offen nt lds
    s_add_u32 s16, s16, s17
    s_sub_u32 s19, s19, 1
    s_cmp_lg_u32 s19, 0
    s_cbranch_scc1 L_dma_late
    s_waitcnt vmcnt(4)
    s_barrier
L_wt:
    v_add_u32 v9, 16384, v2
    v_add_u32 v10, 53248, v2
    ds_read_b64_tr_b16 v[96:97], v9 offset:0
    ds_read_b64_tr_b16 v[98:99], v9 offset:512
    ds_read_b64_tr_b16 v[100:101], v9 offset:4096
    ds_read_b64_tr_b16 v[102:103], v9 offset:4608
    ds_read_b64_tr_b16 v[104:105], v9 offset:8192
    ds_read_b64_tr_b16 v[106:107], v9 offset:8704
    ds_read_b64_tr_b16 v[108:109], v9 offset:12288
    ds_read_b64_tr_b16 v[110:111], v9 offset:12800
    ds_read_b64_tr_b16 v[112:113], v9 offset:16384
    ds_read_b64_tr_b16 v[114:115], v9 offset:16896
    ds_read_b64_tr_b16 v[116:117], v9 offset:20480
    ds_read_b64_tr_b16 v[118:119], v9 offset:20992
    ds_read_b64_tr_b16 v[120:121], v9 offset:24576
    ds_read_b64_tr_b16 v[122:123], v9 offset:25088
    ds_read_b64_tr_b16 v[124:125], v9 offset:28672
    ds_read_b64_tr_b16 v[126:127], v9 offset:29184
    ds_read_b64_tr_b16 v[128:129], v9 offset:32768
    ds_read_b64_tr_b16 v[130:131], v9 offset:33280
    ds_read_b64_tr_b16 v[132:133], v10 offset:0
    ds_read_b64_tr_b16 v[134:135], v10 offset:512
    ds_read_b64_tr_b16 v[136:137], v10 offset:4096
    ds_read_b64_tr_b16 v[138:139], v10 offset:4608
    ds_read_b64_tr_b16 v[140:141], v10 offset:8192
    ds_read_b64_tr_b16 v[142:143], v10 offset:8704
    ds_read_b64_tr_b16 v[144:145], v10 offset:12288
    ds_read_b64_tr_b16 v[146:147], v10 offset:12800
    ds_read_b64_tr_b16 v[148:149], v10 offset:16384
    ds_read_b64_tr_b16 v[150:151], v10 offset:16896
    s_waitcnt vmcnt(1)
    buffer_load_dwordx4 v[84:87], v12, s[24:27], s65 offen sc1
    s_cbranch_execz L_wt2
    s_waitcnt vmcnt(1)
    s_barrier
L_wt2:
    v_add_u32 v9, 16384, v2
    v_add_u32 v10, 53248, v2
    ds_read_b64_tr_b16 v[152:153], v10 offset:20480
    ds_read_b64_tr_b16 v[154:155], v10 offset:20992
    ds_read_b64_tr_b16 v[156:157], v10 offset:24576
    ds_read_b64_tr_b16 v[158:159], v10 offset:25088
    ds_read_b64_tr_b16 v[160:161], v10 offset:28672
    ds_read_b64_tr_b16 v[162:163], v10 offset:29184
    ds_read_b64_tr_b16 v[164:165], v10 offset:32768
    ds_read_b64_tr_b16 v[166:167], v10 offset:33280
    s_mov_b32 s7, 0
L_zpl:
    s_waitcnt vmcnt(0)
    ds_write_b128 v12, v[84:87] offset:5888
    v_max3_u32 v8, v84, v85, v86
    v_max_u32 v8, v8, v87
    v_cmp_eq_u32 vcc, -1, v8
    s_nop 0
    s_cbranch_vccz L_zok
    buffer_load_dwordx4 v[84:87], v12, s[24:27], s65 offen sc1
    s_add_u32 s7, s7, 1
    s_cmp_lt_u32 s7, 131072
    s_cbranch_scc1 L_zpl
L_zok:
    s_waitcnt lgkmcnt(0)
    s_cbranch_execz L_lv_123
    s_barrier
L_lv_123:
    ds_read_b128 v[24:27], v4 offset:0
    ds_read_b128 v[28:31], v4 offset:64
    ds_read_b128 v[20:23], v16
    ds_read_b128 v[32:35], v4 offset:128
    ds_read_b128 v[36:39], v4 offset:192
    ds_read_b128 v[40:43], v4 offset:256
    ds_read_b128 v[44:47], v4 offset:320
    s_waitcnt lgkmcnt(6)
    v_mfma_f32_16x16x32_bf16 v[8:11], v[24:27], v[96:99], 0
    ds_read_b128 v[48:51], v4 offset:384
    s_waitcnt lgkmcnt(6)
    v_mfma_f32_16x16x32_bf16 v[8:11], v[28:31], v[100:103], v[8:11]
    ds_read_b128 v[52:55], v4 offset:448
    s_waitcnt lgkmcnt(5)
    v_mfma_f32_16x16x32_bf16 v[8:11], v[32:35], v[104:107], v[8:11]
    ds_read_b128 v[56:59], v4 offset:512
    v_pk_add_f32 v[18:19], v[20:21], v[22:23]
    s_waitcnt lgkmcnt(5)
    v_mfma_f32_16x16x32_bf16 v[8:11], v[36:39], v[108:111], v[8:11]
    ds_read_b128 v[60:63], v4 offset:576
    s_waitcnt vmcnt(0)
    s_waitcnt lgkmcnt(5)
    v_mfma_f32_16x16x32_bf16 v[8:11], v[40:43], v[112:115], v[8:11]
    ds_read_b128 v[64:67], v4 offset:640
    v_permlane32_swap_b32 v18, v19
    s_waitcnt lgkmcnt(5)
    v_mfma_f32_16x16x32_bf16 v[8:11], v[44:47], v[116:119], v[8:11]
    ds_read_b128 v[68:71], v4 offset:704
    v_add_f32 v18, v18, v19
    s_waitcnt lgkmcnt(5)
    v_mfma_f32_16x16x32_bf16 v[8:11], v[48:51], v[120:123], v[8:11]
    ds_read_b128 v[72:75], v4 offset:768
    v_add_f32_dpp v18, v18, v18 row_ror:1 row_mask:0xf bank_mask:0xf
    s_waitcnt lgkmcnt(5)
    v_mfma_f32_16x16x32_bf16 v[8:11], v[52:55], v[124:127], v[8:11]
    ds_read_b128 v[76:79], v4 offset:832
    v_add_f32_dpp v18, v18, v18 row_ror:2 row_mask:0xf bank_mask:0xf
    s_waitcnt lgkmcnt(5)
    v_mfma_f32_16x16x32_bf16 v[8:11], v[56:59], v[128:131], v[8:11]
    ds_read_b128 v[80:83], v4 offset:896
    v_add_f32_dpp v18, v18, v18 row_ror:4 row_mask:0xf bank_mask:0xf
    s_waitcnt lgkmcnt(5)
    v_mfma_f32_16x16x32_bf16 v[8:11], v[60:63], v[132:135], v[8:11]
    ds_read_b128 v[84:87], v4 offset:960
    v_add_f32_dpp v18, v18, v18 row_ror:8 row_mask:0xf bank_mask:0xf
    s_waitcnt lgkmcnt(5)
    v_mfma_f32_16x16x32_bf16 v[8:11], v[64:67], v[136:139], v[8:11]
    ds_read_b128 v[88:91], v4 offset:1024
    v_mul_f32 v18, s68, v18
    s_waitcnt lgkmcnt(5)
    v_mfma_f32_16x16x32_bf16 v[8:11], v[68:71], v[140:143], v[8:11]
    ds_read_b128 v[92:95], v4 offset:1088
    v_mov_b32 v19, v18
    s_waitcnt lgkmcnt(5)
    v_mfma_f32_16x16x32_bf16 v[8:11], v[72:75], v[144:147], v[8:11]
    v_permlane32_swap_b32 v18, v19
    s_waitcnt lgkmcnt(4)
    v_mfma_f32_16x16x32_bf16 v[8:11], v[76:79], v[148:151], v[8:11]
    v_fma_f32 v19, -v18, v18, v19
    s_waitcnt lgkmcnt(3)
    v_mfma_f32_16x16x32_bf16 v[8:11], v[80:83], v[152:155], v[8:11]
    v_max_f32 v19, 0, v19
    s_waitcnt lgkmcnt(2)
    v_mfma_f32_16x16x32_bf16 v[8:11], v[84:87], v[156:159], v[8:11]
    v_add_f32 v19, s69, v19
    s_waitcnt lgkmcnt(1)
    v_mfma_f32_16x16x32_bf16 v[8:11], v[88:91], v[160:163], v[8:11]
    v_rsq_f32 v19, v19
    s_waitcnt lgkmcnt(0)
    v_mfma_f32_16x16x32_bf16 v[8:11], v[92:95], v[164:167], v[8:11]
    s_nop 7
    v_fma_f32 v8, -v18, v9, v8
    v_fma_f32 v8, v8, v19, v10
    v_mov_b32 v9, v8
    s_nop 1
    v_permlane16_swap_b32 v8, v9
    v_and_or_b32 v8, v8, s90, v5
    s_and_b64 exec, s[88:89], 0xffff
    s_cmp_eq_u32 s6, 3
    s_cbranch_scc0 L_is_124
    buffer_store_dwordx2 v[8:9], v7, s[24:27], s64 offen
L_isd_125:
    s_mov_b64 exec, s[88:89]
    s_sub_u32 s28, s5, 15
    s_cmp_ge_u32 s28, 4
    s_cbranch_scc1 L_wend
L_w2t:
    s_cbranch_execz L_lv_126
    s_barrier
L_lv_126:
    v_add_u32 v5, 90112, v2
    v_add_u32 v6, 126976, v2
    ds_read_b64_tr_b16 v[96:97], v5 offset:0
    ds_read_b64_tr_b16 v[98:99], v5 offset:512
    ds_read_b64_tr_b16 v[100:101], v5 offset:4096
    ds_read_b64_tr_b16 v[102:103], v5 offset:4608
    ds_read_b64_tr_b16 v[104:105], v5 offset:8192
    ds_read_b64_tr_b16 v[106:107], v5 offset:8704
    ds_read_b64_tr_b16 v[108:109], v5 offset:12288
    ds_read_b64_tr_b16 v[110:111], v5 offset:12800
    ds_read_b64_tr_b16 v[112:113], v5 offset:16384
    ds_read_b64_tr_b16 v[114:115], v5 offset:16896
    ds_read_b64_tr_b16 v[116:117], v5 offset:20480
    ds_read_b64_tr_b16 v[118:119], v5 offset:20992
    ds_read_b64_tr_b16 v[120:121], v5 offset:24576
    ds_read_b64_tr_b16 v[122:123], v5 offset:25088
    ds_read_b64_tr_b16 v[124:125], v5 offset:28672
    ds_read_b64_tr_b16 v[126:127], v5 offset:29184
    ds_read_b64_tr_b16 v[128:129], v5 offset:32768
    ds_read_b64_tr_b16 v[130:131], v5 offset:33280
    ds_read_b64_tr_b16 v[132:133], v6 offset:0
    ds_read_b64_tr_b16 v[134:135], v6 offset:512
    ds_read_b64_tr_b16 v[136:137], v6 offset:4096
    ds_read_b64_tr_b16 v[138:139], v6 offset:4608
    ds_read_b64_tr_b16 v[140:141], v6 offset:8192
    ds_read_b64_tr_b16 v[142:143], v6 offset:8704
    ds_read_b64_tr_b16 v[144:145], v6 offset:12288
    ds_read_b64_tr_b16 v[146:147], v6 offset:12800
    ds_read_b64_tr_b16 v[148:149], v6 offset:16384
    ds_read_b64_tr_b16 v[150:151], v6 offset:16896
    ds_read_b64_tr_b16 v[152:153], v6 offset:20480
    ds_read_b64_tr_b16 v[154:155], v6 offset:20992
    ds_read_b64_tr_b16 v[156:157], v6 offset:24576
    ds_read_b64_tr_b16 v[158:159], v6 offset:25088
    ds_read_b64_tr_b16 v[160:161], v6 offset:28672
    ds_read_b64_tr_b16 v[162:163], v6 offset:29184
    ds_read_b64_tr_b16 v[164:165], v6 offset:32768
    ds_read_b64_tr_b16 v[166:167], v6 offset:33280
    s_waitcnt lgkmcnt(0)
    v_and_b32 v5, 3, v0
    v_mul_u32_u24 v5, 7, v5
    v_bfe_u32 v5, s35, v5, 12
    s_cbranch_execz L_lv_127
    s_barrier
L_lv_127:
    ds_read_b128 v[24:27], v3 offset:64
    ds_read_b128 v[28:31], v3 offset:128
    ds_read_b128 v[32:35], v3 offset:192
    ds_read_b128 v[36:39], v3 offset:256
    ds_read_b128 v[40:43], v3 offset:320
    ds_read_b128 v[44:47], v3 offset:384
    s_waitcnt lgkmcnt(5)
    v_mfma_f32_16x16x32_bf16 v[8:11], v[24:27], v[96:99], 0
    ds_read_b128 v[48:51], v3 offset:448
    s_waitcnt lgkmcnt(5)
    v_mfma_f32_16x16x32_bf16 v[8:11], v[28:31], v[100:103], v[8:11]
    ds_read_b128 v[52:55], v3 offset:512
    s_waitcnt lgkmcnt(5)
    v_mfma_f32_16x16x32_bf16 v[8:11], v[32:35], v[104:107], v[8:11]
    ds_read_b128 v[56:59], v3 offset:576
    s_waitcnt lgkmcnt(5)
    v_mfma_f32_16x16x32_bf16 v[8:11], v[36:39], v[108:111], v[8:11]
    ds_read_b128 v[60:63], v3 offset:640
    s_waitcnt lgkmcnt(5)
    v_mfma_f32_16x16x32_bf16 v[8:11], v[40:43], v[112:115], v[8:11]
    ds_read_b128 v[64:67], v3 offset:704
    s_waitcnt lgkmcnt(5)
    v_mfma_f32_16x16x32_bf16 v[8:11], v[44:47], v[116:119], v[8:11]
    ds_read_b128 v[68:71], v3 offset:768
    s_waitcnt lgkmcnt(5)
    v_mfma_f32_16x16x32_bf16 v[8:11], v[48:51], v[120:123], v[8:11]
    ds_read_b128 v[72:75], v3 offset:832
    s_waitcnt lgkmcnt(5)
    v_mfma_f32_16x16x32_bf16 v[8:11], v[52:55], v[124:127], v[8:11]
    ds_read_b128 v[76:79], v3 offset:896
    s_waitcnt lgkmcnt(5)
    v_mfma_f32_16x16x32_bf16 v[8:11], v[56:59], v[128:131], v[8:11]
    ds_read_b128 v[80:83], v3 offset:960
    s_waitcnt lgkmcnt(5)
    v_mfma_f32_16x16x32_bf16 v[8:11], v[60:63], v[132:135], v[8:11]
    ds_read_b128 v[84:87], v3 offset:1024
    s_waitcnt lgkmcnt(5)
    v_mfma_f32_16x16x32_bf16 v[8:11], v[64:67], v[136:139], v[8:11]
    ds_read_b128 v[88:91], v3 offset:1088
    s_waitcnt lgkmcnt(5)
    v_mfma_f32_16x16x32_bf16 v[8:11], v[68:71], v[140:143], v[8:11]
    ds_read_b128 v[92:95], v3 offset:1152
    s_waitcnt lgkmcnt(5)
    v_mfma_f32_16x16x32_bf16 v[8:11], v[72:75], v[144:147], v[8:11]
    s_waitcnt lgkmcnt(4)
    v_mfma_f32_16x16x32_bf16 v[8:11], v[76:79], v[148:151], v[8:11]
    s_waitcnt lgkmcnt(3)
    v_mfma_f32_16x16x32_bf16 v[8:11], v[80:83], v[152:155], v[8:11]
    s_waitcnt lgkmcnt(2)
    v_mfma_f32_16x16x32_bf16 v[8:11], v[84:87], v[156:159], v[8:11]
    s_waitcnt lgkmcnt(1)
    v_mfma_f32_16x16x32_bf16 v[8:11], v[88:91], v[160:163], v[8:11]
    s_waitcnt lgkmcnt(0)
    v_mfma_f32_16x16x32_bf16 v[8:11], v[92:95], v[164:167], v[8:11]
    s_nop 7
    v_and_or_b32 v8, v8, s90, v5
    s_and_b64 exec, s[88:89], 0xffff
    buffer_store_dwordx2 v[8:9], v7, s[24:27], s66 offen sc1
    buffer_store_dwordx2 v[8:9], v7, s[24:27], s70 offen sc1
L_wend:
    s_cbranch_execnz L_svc_end
    s_cmp_ge_u32 s5, 27
    s_cbranch_scc1 L_ret_l
    s_branch L_ret_w
L_w2late:
    s_waitcnt lgkmcnt(0)
    s_mul_i32 s35, s34, 0x9E3779B1
    s_add_u32 s35, s35, 0x7F4A7C15
    s_mov_b32 s90, 0xfffff000
    v_bfe_u32 v4, v0, 2, 2
    v_lshrrev_b32 v5, 4, v0
    v_lshl_add_u32 v4, v5, 3, v4
    v_lshlrev_b32 v4, 7, v4
    v_and_b32 v6, 3, v0
    v_lshl_add_u32 v4, v6, 3, v4
    v_bfe_u32 v7, v0, 3, 2
    v_xor_b32 v7, s3, v7
    v_lshl_add_u32 v2, v7, 5, v4
    v_and_b32 v3, 1, v0
    v_mul_u32_u24 v3, 1152, v3
    v_lshl_add_u32 v3, v5, 4, v3
    v_mov_b32 v8, 5888
    v_mov_b32 v9, 1216
    v_mov_b32 v10, 3552
    v_cmp_eq_u32 vcc, 1, v6
    s_nop 1
    v_cndmask_b32 v4, v8, v9, vcc
    v_cmp_eq_u32 vcc, 2, v6
    s_nop 1
    v_cndmask_b32 v4, v4, v10, vcc
    v_bfe_u32 v7, v0, 2, 1
    v_mul_u32_u24 v7, 1152, v7
    v_lshl_add_u32 v7, v5, 4, v7
    v_add_u32 v4, v4, v7
    v_and_b32 v3, 1, v0
    v_xor_b32 v3, 1, v3
    v_mul_u32_u24 v3, 15040, v3
    v_lshl_add_u32 v3, v5, 4, v3
    s_sub_u32 s30, s5, 9
    s_lshr_b32 s30, s30, 1
    s_sub_u32 s7, 3, s4
    s_and_b32 s7, s7, 7
    s_add_u32 s30, s30, s7
    s_cmp_ge_u32 s30, 9
    s_cselect_b32 s7, 9, 0
    s_sub_u32 s30, s30, s7
    s_bitcmp0_b32 s5, 0
    s_cselect_b32 s29, 9, 0
    s_add_u32 s30, s30, s29
    s_lshl_b32 s30, s30, 2
    s_add_u32 s30, s30, s3
    s_lshl_b32 s64, s30, 7
    s_mul_i32 s29, s4, 9216
    s_add_u32 s64, s64, s29
    s_add_u32 s64, s64, 262144
    s_mul_i32 s65, s4, 3072
    s_add_u32 s65, s65, 409600
    s_sub_u32 s30, s5, 15
    s_cmp_lt_u32 s30, 4
    s_cselect_b32 s30, s30, 9
    s_sub_u32 s7, s5, 23
    s_cmp_ge_u32 s5, 27
    s_cselect_b32 s30, s7, s30
    s_lshl_b32 s30, s30, 2
    s_add_u32 s30, s30, s3
    s_lshl_b32 s30, s30, 7
    s_lshl_b32 s66, s4, 14
    s_add_u32 s66, s66, s30
    s_add_u32 s66, s66, 655360
    s_add_u32 s70, s66, 8192
    s_mul_i32 s28, s3, 45
    v_min_u32 v12, 44, v0
    v_add_u32 v12, s28, v12
    v_lshlrev_b32 v12, 4, v12
    v_and_b32 v8, 15, v0
    v_lshrrev_b32 v9, 5, v0
    v_lshl_add_u32 v9, v9, 4, v8
    v_cmp_gt_u32 vcc, 18, v9
    v_bfe_u32 v10, v0, 4, 1
    v_mul_u32_u24 v11, 288, v10
    v_lshl_add_u32 v16, v9, 4, v11
    v_add_u32 v16, 8192, v16
    v_mov_b32 v9, 5856
    v_cndmask_b32 v16, v9, v16, vcc
    v_and_b32 v8, 3, v0
    v_lshlrev_b32 v8, 2, v8
    ds_write_b32 v8, v1 offset:5856
    v_lshlrev_b32 v7, 3, v0
    s_mov_b32 s68, 0x3ae38e39
    s_mov_b32 s69, 0x3727c5ac
    s_cmp_lg_u32 s3, 1
    s_cbranch_scc1 L_now_l
    s_mov_b64 s[88:89], 0
    s_mov_b64 exec, 0
    s_branch L_w2t
L_ret_l:
    s_mov_b64 s[88:89], -1
    s_mov_b64 exec, -1
L_now_l:
    s_mov_b32 s20, 1152
    v_lshrrev_b32 v26, 3, v0
    v_mul_lo_u32 v26, v26, s20
    v_and_b32 v24, 7, v0
    v_bfe_u32 v25, v0, 4, 1
    v_lshlrev_b32 v25, 1, v25
    v_xor_b32 v24, v24, v25
    v_xor_b32 v25, 4, v24
    v_lshl_add_u32 v24, v24, 4, v26
    v_lshl_add_u32 v25, v25, 4, v26
    s_lshl_b32 s17, s20, 3
    s_mov_b32 s8, s52
    s_mov_b32 s9, s53
    s_mov_b32 s10, 5308416
    s_mov_b32 s11, 0x20000
    s_lshl_b32 s28, s4, 2
    s_add_u32 s28, s28, s3
    s_mul_i32 s16, s28, 165888
    s_sub_u32 s28, s5, 23
    s_lshl_b32 s28, s28, 7
    s_add_u32 s16, s16, s28
    s_mul_i32 s29, s3, 18432
    s_add_u32 s29, s29, 90112
    s_mov_b32 s19, 9
    s_lshl_b32 s30, s21, 1
    s_mov_b32 s7, 0
L_lw_128:
    ds_read_b32 v8, v1 offset:24
    s_waitcnt lgkmcnt(0)
    v_readfirstlane_b32 s28, v8
    s_nop 0
    s_cmp_ge_u32 s28, s30
    s_cbranch_scc1 L_lwd_129
    s_sleep 2
    s_add_u32 s7, s7, 1
    s_cmp_lt_u32 s7, 1048576
    s_cbranch_scc1 L_lw_128
L_lwd_129:
    s_mov_b32 s7, 0
L_lw_130:
    ds_read_b32 v8, v1 offset:44
    s_waitcnt lgkmcnt(0)
    v_readfirstlane_b32 s28, v8
    s_nop 0
    s_cmp_ge_u32 s28, 9
    s_cbranch_scc1 L_lwd_131
    s_sleep 2
    s_add_u32 s7, s7, 1
    s_cmp_lt_u32 s7, 1048576
    s_cbranch_scc1 L_lw_130
L_lwd_131:
    s_cmp_lg_u32 s3, 1
    s_cbranch_scc1 L_wl2
    v_and_b32 v9, 31, v0
    v_lshlrev_b32 v9, 10, v9
    s_lshl_b32 s30, s4, 15
    s_and_b32 s31, s35, 0xfff
    s_mov_b32 s7, 0
L_wlp:
    buffer_load_dword v8, v9, s[24:27], s30 offen sc1
    s_waitcnt vmcnt(0)
    v_and_b32 v8, 0xfff, v8
    v_cmp_eq_u32 vcc, s31, v8
    s_nop 0
    s_bcnt1_i32_b64 s28, vcc
    s_cmp_ge_u32 s28, 40
    s_cbranch_scc1 L_wld
    s_sleep 4
    s_add_u32 s7, s7, 1
    s_cmp_lt_u32 s7, 131072
    s_cbranch_scc1 L_wlp
L_wld:
    v_mov_b32 v8, 1
    ds_write_b32 v1, v8 offset:12
L_wl2:
    s_mov_b32 s7, 0
L_lw_132:
    ds_read_b32 v8, v1 offset:12
    s_waitcnt lgkmcnt(0)
    v_readfirstlane_b32 s28, v8
    s_nop 0
    s_cmp_ge_u32 s28, 1
    s_cbranch_scc1 L_lwd_133
    s_sleep 1
    s_add_u32 s7, s7, 1
    s_cmp_lt_u32 s7, 1048576
    s_cbranch_scc1 L_lw_132
L_lwd_133:
    s_setprio 3
L_dma_w2l:
    s_mov_b32 m0, s29
    s_add_u32 s29, s29, 1024
    buffer_load_dwordx4 v24, s[8:11], s16 offen nt lds
    s_add_u32 s16, s16, s17
    s_mov_b32 m0, s29
    s_add_u32 s29, s29, 1024
    buffer_load_dwordx4 v25, s[8:11], s16 offen nt lds
    s_add_u32 s16, s16, s17
    s_sub_u32 s19, s19, 1
    s_cmp_lg_u32 s19, 0
    s_cbranch_scc1 L_dma_w2l
    s_waitcnt vmcnt(0)
    s_barrier
    s_branch L_w2t
L_owner:
    s_waitcnt vmcnt(0)
    v_mov_b32 v8, 1
    s_mov_b64 exec, 1
    ds_add_u32 v1, v8 offset:12
    s_mov_b64 exec, -1
    s_waitcnt lgkmcnt(0)
    s_mul_i32 s35, s34, 0x9E3779B1
    s_add_u32 s35, s35, 0x7F4A7C15
    s_mov_b32 s90, 0xfffff000
    v_bfe_u32 v4, v0, 2, 2
    v_lshrrev_b32 v5, 4, v0
    v_lshl_add_u32 v4, v5, 3, v4
    v_lshlrev_b32 v4, 7, v4
    v_and_b32 v6, 3, v0
    v_lshl_add_u32 v4, v6, 3, v4
    v_bfe_u32 v7, v0, 3, 2
    v_xor_b32 v7, s3, v7
    v_lshl_add_u32 v2, v7, 5, v4
    v_and_b32 v3, 1, v0
    v_mul_u32_u24 v3, 1152, v3
    v_lshl_add_u32 v3, v5, 4, v3
    s_lshl_b32 s22, s5, 2
    s_add_u32 s22, s22, s3
    v_and_b32 v6, 15, v0
    v_bfe_u32 v7, v0, 4, 1
    v_lshrrev_b32 v20, 4, v0
    v_lshlrev_b32 v20, 14, v20
    v_lshl_add_u32 v20, v6, 3, v20
    v_mul_u32_u24 v21, 1152, v7
    v_lshl_add_u32 v21, v6, 1, v21
    v_mul_u32_u24 v22, 288, v7
    v_lshlrev_b32 v23, 3, v6
    v_cmp_eq_u32 vcc, 0, v7
    v_mov_b32 v19, 0x03020c0c
    v_mov_b32 v6, 0x01000c0c
    v_cndmask_b32 v19, v19, v6, vcc
    s_lshl_b32 s23, s22, 5
    s_mov_b32 s8, s36
    s_mov_b32 s9, s37
    s_mov_b32 s10, 2304
    s_mov_b32 s11, 0x20000
    s_mov_b32 s12, s58
    s_mov_b32 s13, s59
    s_mov_b32 s14, 2304
    s_mov_b32 s15, 0x20000
    s_lshl_b32 s28, s22, 7
    s_add_u32 s32, s28, 861184
    s_add_u32 s33, s32, 9216
    s_add_u32 s19, s33, 4608
    s_lshl_b32 s29, s4, 14
    s_add_u32 s29, s29, s28
    s_add_u32 s18, s29, 524288
    s_add_u32 s68, s18, 8192
    s_add_u32 s64, s28, 524288
    s_add_u32 s65, s28, 589824
    s_add_u32 s66, s28, 655360
    s_add_u32 s67, s28, 720896
    s_mul_i32 s20, s4, 3072
    s_add_u32 s20, s20, s23
    s_add_u32 s20, s20, 409600
    s_mul_i32 s21, s4, 3072
    s_lshl_b32 s28, s22, 3
    s_add_u32 s21, s21, s28
    s_add_u32 s21, s21, 411904
    v_lshlrev_b32 v7, 3, v0
    v_and_b32 v3, 3, v0
    v_mul_u32_u24 v3, 1088, v3
    v_lshl_add_u32 v3, v5, 4, v3
    s_cmp_lg_u32 s3, 1
    s_cbranch_scc1 L_now_o
    s_mov_b32 s6, 3
    s_mov_b64 s[88:89], 0
    s_mov_b64 exec, 0
    s_branch L_ot
L_ret_o:
    s_mov_b64 s[88:89], -1
    s_mov_b64 exec, -1
L_now_o:
    s_cmp_lg_u32 s3, 2
    s_cbranch_scc1 L_nonuma
    s_lshl_b32 s28, s4, 14
    s_lshl_b32 s29, s5, 8
    s_add_u32 s28, s28, s29
    s_add_u32 s28, s28, 528896
    s_add_u32 s36, s28, 0
    s_add_u32 s37, s36, 8192
    s_add_u32 s38, s28, 131072
    s_add_u32 s39, s38, 8192
    s_add_u32 s40, s28, 1152
    s_add_u32 s41, s40, 8192
    s_add_u32 s42, s28, 132224
    s_add_u32 s43, s42, 8192
    s_buffer_load_dword s44, s[24:27], s36 glc
    s_buffer_load_dword s45, s[24:27], s37 glc
    s_buffer_load_dword s46, s[24:27], s38 glc
    s_buffer_load_dword s47, s[24:27], s39 glc
    s_buffer_load_dword s48, s[24:27], s40 glc
    s_buffer_load_dword s49, s[24:27], s41 glc
    s_buffer_load_dword s50, s[24:27], s42 glc
    s_buffer_load_dword s51, s[24:27], s43 glc
    s_mov_b32 s30, 0
    s_mov_b32 s31, 0
    s_waitcnt lgkmcnt(0)
L_numa:
    s_not_b32 s52, s44
    s_buffer_load_dword s53, s[24:27], s37 glc
    s_buffer_load_dword s52, s[24:27], s36 glc
    s_waitcnt lgkmcnt(1)
    s_nop 7
    s_cmp_lg_u32 s52, s44
    s_addc_u32 s30, s30, 0
    s_waitcnt lgkmcnt(0)
    s_not_b32 s53, s47
    s_buffer_load_dword s52, s[24:27], s38 glc
    s_buffer_load_dword s53, s[24:27], s39 glc
    s_waitcnt lgkmcnt(1)
    s_nop 7
    s_cmp_eq_u32 s53, s47
    s_addc_u32 s30, s30, 0
    s_waitcnt lgkmcnt(0)
    s_not_b32 s52, s48
    s_buffer_load_dword s53, s[24:27], s41 glc
    s_buffer_load_dword s52, s[24:27], s40 glc
    s_waitcnt lgkmcnt(1)
    s_nop 7
    s_cmp_lg_u32 s52, s48
    s_addc_u32 s30, s30, 0
    s_waitcnt lgkmcnt(0)
    s_not_b32 s53, s51
    s_buffer_load_dword s52, s[24:27], s42 glc
    s_buffer_load_dword s53, s[24:27], s43 glc
    s_waitcnt lgkmcnt(1)
    s_nop 7
    s_cmp_eq_u32 s53, s51
    s_addc_u32 s30, s30, 0
    s_waitcnt lgkmcnt(0)
    s_add_u32 s31, s31, 1
    s_cmp_lt_u32 s31, 2
    s_cbranch_scc1 L_numa
    s_lshl_b32 s31, s4, 7
    s_add_u32 s31, s31, 794624
    s_lshl_b32 s29, s5, 3
    s_add_u32 s29, s29, s31
    v_mov_b32 v24, s30
    v_mov_b32 v25, s35
    s_mov_b64 exec, 1
    buffer_store_dwordx2 v[24:25], v1, s[24:27], s29 offen sc1
    s_mov_b64 exec, -1
    s_mov_b32 s7, 0
L_lw_134:
    ds_read_b32 v8, v1 offset:8
    s_waitcnt lgkmcnt(0)
    v_readfirstlane_b32 s28, v8
    s_nop 0
    s_cmp_ge_u32 s28, 8
    s_cbranch_scc1 L_lwd_135
    s_sleep 8
    s_add_u32 s7, s7, 1
    s_cmp_lt_u32 s7, 1048576
    s_cbranch_scc1 L_lw_134
L_lwd_135:
    v_min_u32 v26, 64, v23
    s_mov_b32 s7, 0
L_pl_136:
    buffer_load_dwordx2 v[24:25], v26, s[24:27], s31 offen sc1
    s_waitcnt vmcnt(0)
    v_xor_b32 v27, s35, v25
    v_cmp_ne_u32 vcc, 0, v27
    s_nop 0
    s_cbranch_vccz L_pld_137
    s_sleep 16
    s_add_u32 s7, s7, 1
    s_cmp_lt_u32 s7, 131072
    s_cbranch_scc1 L_pl_136
L_pld_137:
    v_cmp_gt_u32 vcc, 72, v23
    s_nop 1
    v_cndmask_b32 v24, 0, v24, vcc
    s_nop 1
    v_add_u32_dpp v24, v24, v24 row_ror:1 row_mask:0xf bank_mask:0xf
    s_nop 1
    v_add_u32_dpp v24, v24, v24 row_ror:2 row_mask:0xf bank_mask:0xf
    s_nop 1
    v_add_u32_dpp v24, v24, v24 row_ror:4 row_mask:0xf bank_mask:0xf
    s_nop 1
    v_add_u32_dpp v24, v24, v24 row_ror:8 row_mask:0xf bank_mask:0xf
    s_nop 0
    v_readfirstlane_b32 s30, v24
    s_nop 0
    s_cmp_gt_u32 s30, 36
    s_cselect_b32 s30, 8193, 1
    v_mov_b32 v8, s30
    ds_write_b32 v1, v8 offset:60
L_nonuma:
    s_mov_b32 s7, 0
L_lw_138:
    ds_read_b32 v8, v1 offset:0
    s_waitcnt lgkmcnt(0)
    v_readfirstlane_b32 s28, v8
    s_nop 0
    s_cmp_ge_u32 s28, 1
    s_cbranch_scc1 L_lwd_139
    s_sleep 8
    s_add_u32 s7, s7, 1
    s_cmp_lt_u32 s7, 1048576
    s_cbranch_scc1 L_lw_138
L_lwd_139:
    s_mov_b32 s6, s28
    s_mov_b32 s7, 0
L_lw_140:
    ds_read_b32 v8, v1 offset:12
    s_waitcnt lgkmcnt(0)
    v_readfirstlane_b32 s28, v8
    s_nop 0
    s_cmp_ge_u32 s28, 4
    s_cbranch_scc1 L_lwd_141
    s_sleep 4
    s_add_u32 s7, s7, 1
    s_cmp_lt_u32 s7, 1048576
    s_cbranch_scc1 L_lw_140
L_lwd_141:
    v_add_u32 v5, 16384, v2
    v_add_u32 v6, 53248, v2
    ds_read_b64_tr_b16 v[96:97], v5 offset:0
    ds_read_b64_tr_b16 v[98:99], v5 offset:512
    ds_read_b64_tr_b16 v[100:101], v5 offset:4096
    ds_read_b64_tr_b16 v[102:103], v5 offset:4608
    ds_read_b64_tr_b16 v[104:105], v5 offset:8192
    ds_read_b64_tr_b16 v[106:107], v5 offset:8704
    ds_read_b64_tr_b16 v[108:109], v5 offset:12288
    ds_read_b64_tr_b16 v[110:111], v5 offset:12800
    ds_read_b64_tr_b16 v[112:113], v5 offset:16384
    ds_read_b64_tr_b16 v[114:115], v5 offset:16896
    ds_read_b64_tr_b16 v[116:117], v5 offset:20480
    ds_read_b64_tr_b16 v[118:119], v5 offset:20992
    ds_read_b64_tr_b16 v[120:121], v5 offset:24576
    ds_read_b64_tr_b16 v[122:123], v5 offset:25088
    ds_read_b64_tr_b16 v[124:125], v5 offset:28672
    ds_read_b64_tr_b16 v[126:127], v5 offset:29184
    ds_read_b64_tr_b16 v[128:129], v5 offset:32768
    ds_read_b64_tr_b16 v[130:131], v5 offset:33280
    ds_read_b64_tr_b16 v[132:133], v6 offset:0
    ds_read_b64_tr_b16 v[134:135], v6 offset:512
    ds_read_b64_tr_b16 v[136:137], v6 offset:4096
    ds_read_b64_tr_b16 v[138:139], v6 offset:4608
    ds_read_b64_tr_b16 v[140:141], v6 offset:8192
    ds_read_b64_tr_b16 v[142:143], v6 offset:8704
    ds_read_b64_tr_b16 v[144:145], v6 offset:12288
    ds_read_b64_tr_b16 v[146:147], v6 offset:12800
    ds_read_b64_tr_b16 v[148:149], v6 offset:16384
    ds_read_b64_tr_b16 v[150:151], v6 offset:16896
    ds_read_b64_tr_b16 v[152:153], v6 offset:20480
    ds_read_b64_tr_b16 v[154:155], v6 offset:20992
    ds_read_b64_tr_b16 v[156:157], v6 offset:24576
    ds_read_b64_tr_b16 v[158:159], v6 offset:25088
    s_waitcnt lgkmcnt(0)
    buffer_load_ushort v16, v21, s[8:11], s23 offen
    v_lshrrev_b32 v28, 5, v0
    v_lshlrev_b32 v28, 6, v28
    v_and_b32 v29, 15, v0
    v_lshl_add_u32 v28, v29, 1, v28
    v_add_u32 v28, v28, v21
    buffer_load_dword v2, v28, s[8:11], 0 offen
    s_mov_b32 s7, 0
L_pl_142:
    buffer_load_dwordx2 v[24:25], v23, s[24:27], s32 offen sc1
    buffer_load_dwordx2 v[26:27], v23, s[24:27], s33 offen sc1
    s_waitcnt vmcnt(0)
    v_xor_b32 v6, s35, v25
    v_bitop3_b32 v6, v6, v27, s35 bitop3:0xf6
    v_cmp_ne_u32 vcc, 0, v6
    s_nop 0
    s_cbranch_vccz L_pld_143
    s_sleep 8
    s_add_u32 s7, s7, 1
    s_cmp_lt_u32 s7, 131072
    s_cbranch_scc1 L_pl_142
L_pld_143:
    v_perm_b32 v17, v24, v24, v19
    v_perm_b32 v18, v26, v26, v19
    v_lshlrev_b32 v16, 16, v16
    v_add_f32 v18, 1.0, v18
    v_cvt_pk_bf16_f32 v18, v18, v18
    v_and_b32 v18, 0xffff0000, v18
    v_lshlrev_b32 v28, 16, v2
    v_and_b32 v2, 0xffff0000, v2
    v_add_f32 v2, v2, v28
    s_nop 1
    v_add_f32_dpp v2, v2, v2 row_ror:1 row_mask:0xf bank_mask:0xf
    s_nop 1
    v_add_f32_dpp v2, v2, v2 row_ror:2 row_mask:0xf bank_mask:0xf
    s_nop 1
    v_add_f32_dpp v2, v2, v2 row_ror:4 row_mask:0xf bank_mask:0xf
    s_nop 1
    v_add_f32_dpp v2, v2, v2 row_ror:8 row_mask:0xf bank_mask:0xf
    v_mov_b32 v28, v2
    s_nop 1
    v_permlane32_swap_b32 v2, v28
    v_add_f32 v2, v2, v28
    v_mul_f32 v2, 0x3c800000, v2
    s_mov_b32 s7, 0
L_lw_144:
    ds_read_b32 v8, v1 offset:52
    s_waitcnt lgkmcnt(0)
    v_readfirstlane_b32 s28, v8
    s_nop 0
    s_cmp_ge_u32 s28, 1
    s_cbranch_scc1 L_lwd_145
    s_sleep 8
    s_add_u32 s7, s7, 1
    s_cmp_lt_u32 s7, 1048576
    s_cbranch_scc1 L_lw_144
L_lwd_145:
    s_lshl_b32 s28, s4, 5
    s_lshl_b32 s29, s3, 3
    s_add_u32 s28, s28, s29
    s_lshl_b32 s28, s28, 5
    s_add_u32 s28, s28, 442368
    v_and_b32 v28, 15, v0
    v_lshlrev_b32 v28, 4, v28
    v_and_b32 v4, 3, v0
    v_mul_u32_u24 v4, 7, v4
    v_bfe_u32 v4, s35, v4, 12
    s_mov_b32 s7, 0
L_pl_146:
    buffer_load_dwordx4 v[24:27], v28, s[24:27], s28 offen sc1
    s_waitcnt vmcnt(0)
    v_xor_b32 v29, s35, v26
    v_cmp_ne_u32 vcc, 0, v29
    s_nop 0
    s_cbranch_vccz L_pld_147
    s_sleep 8
    s_add_u32 s7, s7, 1
    s_cmp_lt_u32 s7, 131072
    s_cbranch_scc1 L_pl_146
L_pld_147:
    s_mov_b32 s31, 1069066811
    v_mov_b32 v27, v24
    s_nop 1
    v_max_f32_dpp v27, v27, v27 row_ror:2 row_mask:0xf bank_mask:0xf
    s_nop 1
    v_max_f32_dpp v27, v27, v27 row_ror:4 row_mask:0xf bank_mask:0xf
    s_nop 1
    v_max_f32_dpp v27, v27, v27 row_ror:8 row_mask:0xf bank_mask:0xf
    v_sub_f32 v27, v24, v27
    v_mul_f32 v27, s31, v27
    v_exp_f32 v27, v27
    s_nop 0
    v_mul_f32 v28, v27, v25
    s_nop 1
    v_add_f32_dpp v28, v28, v28 row_ror:2 row_mask:0xf bank_mask:0xf
    s_nop 1
    v_add_f32_dpp v28, v28, v28 row_ror:4 row_mask:0xf bank_mask:0xf
    s_nop 1
    v_add_f32_dpp v28, v28, v28 row_ror:8 row_mask:0xf bank_mask:0xf
    v_rcp_f32 v28, v28
    v_and_b32 v26, 1, v0
    v_lshlrev_b32 v26, 5, v26
    v_bfe_u32 v29, v0, 1, 3
    v_lshl_add_u32 v26, v29, 2, v26
    s_lshl_b32 s28, s3, 6
    v_add_u32 v26, s28, v26
    v_mul_f32 v27, v27, v28
    ds_write_b32 v26, v27 offset:768
    v_mov_b32 v24, 1
    s_mov_b64 exec, 1
    ds_add_u32 v1, v24 offset:56
    s_mov_b64 exec, -1
    s_mov_b32 s7, 0
L_lw_148:
    ds_read_b32 v24, v1 offset:60
    s_waitcnt lgkmcnt(0)
    v_readfirstlane_b32 s28, v24
    s_nop 0
    s_cmp_ge_u32 s28, 1
    s_cbranch_scc1 L_lwd_149
    s_sleep 4
    s_add_u32 s7, s7, 1
    s_cmp_lt_u32 s7, 1048576
    s_cbranch_scc1 L_lw_148
L_lwd_149:
    s_sub_u32 s28, s28, 1
    v_add_u32 v20, s28, v20
    s_setprio 3
    s_waitcnt lgkmcnt(0)
    s_barrier
L_ot:
    ds_read_b128 v[24:27], v3 offset:1216
    ds_read_b128 v[28:31], v3 offset:1280
    ds_read_b128 v[32:35], v3 offset:1344
    ds_read_b128 v[36:39], v3 offset:1408
    ds_read_b128 v[40:43], v3 offset:1472
    ds_read_b128 v[44:47], v3 offset:1536
    s_waitcnt lgkmcnt(5)
    v_mfma_f32_16x16x32_bf16 v[8:11], v[24:27], v[96:99], 0
    ds_read_b128 v[48:51], v3 offset:1600
    s_waitcnt lgkmcnt(5)
    v_mfma_f32_16x16x32_bf16 v[8:11], v[28:31], v[100:103], v[8:11]
    ds_read_b128 v[52:55], v3 offset:1664
    s_waitcnt lgkmcnt(5)
    v_mfma_f32_16x16x32_bf16 v[8:11], v[32:35], v[104:107], v[8:11]
    ds_read_b128 v[56:59], v3 offset:1728
    s_waitcnt lgkmcnt(5)
    v_mfma_f32_16x16x32_bf16 v[8:11], v[36:39], v[108:111], v[8:11]
    ds_read_b128 v[60:63], v3 offset:1792
    s_waitcnt lgkmcnt(5)
    v_mfma_f32_16x16x32_bf16 v[8:11], v[40:43], v[112:115], v[8:11]
    ds_read_b128 v[64:67], v3 offset:1856
    s_waitcnt lgkmcnt(5)
    v_mfma_f32_16x16x32_bf16 v[8:11], v[44:47], v[116:119], v[8:11]
    ds_read_b128 v[68:71], v3 offset:1920
    s_waitcnt lgkmcnt(5)
    v_mfma_f32_16x16x32_bf16 v[8:11], v[48:51], v[120:123], v[8:11]
    ds_read_b128 v[72:75], v3 offset:1984
    s_waitcnt lgkmcnt(5)
    v_mfma_f32_16x16x32_bf16 v[8:11], v[52:55], v[124:127], v[8:11]
    ds_read_b128 v[76:79], v3 offset:2048
    s_waitcnt lgkmcnt(5)
    v_mfma_f32_16x16x32_bf16 v[8:11], v[56:59], v[128:131], v[8:11]
    ds_read_b128 v[80:83], v3 offset:2112
    s_waitcnt lgkmcnt(5)
    v_mfma_f32_16x16x32_bf16 v[8:11], v[60:63], v[132:135], v[8:11]
    ds_read_b128 v[84:87], v3 offset:2176
    s_waitcnt lgkmcnt(5)
    v_mfma_f32_16x16x32_bf16 v[8:11], v[64:67], v[136:139], v[8:11]
    s_waitcnt lgkmcnt(4)
    v_mfma_f32_16x16x32_bf16 v[8:11], v[68:71], v[140:143], v[8:11]
    s_waitcnt lgkmcnt(3)
    v_mfma_f32_16x16x32_bf16 v[8:11], v[72:75], v[144:147], v[8:11]
    s_waitcnt lgkmcnt(2)
    v_mfma_f32_16x16x32_bf16 v[8:11], v[76:79], v[148:151], v[8:11]
    s_waitcnt lgkmcnt(1)
    v_mfma_f32_16x16x32_bf16 v[8:11], v[80:83], v[152:155], v[8:11]
    s_waitcnt lgkmcnt(0)
    v_mfma_f32_16x16x32_bf16 v[8:11], v[84:87], v[156:159], v[8:11]
    s_nop 7
    v_pk_add_f32 v[8:9], v[8:9], v[10:11]
    v_and_or_b32 v8, v8, s90, v4
    s_and_b64 exec, s[88:89], 0xffff
    buffer_store_dwordx2 v[8:9], v7, s[24:27], s18 offen sc1
    buffer_store_dwordx2 v[8:9], v7, s[24:27], s68 offen sc1
    s_mov_b64 exec, s[88:89]
    s_mov_b32 s7, 0
    buffer_load_dwordx2 v[32:33], v20, s[24:27], s64 offen sc1
    buffer_load_dwordx2 v[34:35], v20, s[24:27], s65 offen sc1
    buffer_load_dwordx2 v[36:37], v20, s[24:27], s64 offen sc1
    buffer_load_dwordx2 v[38:39], v20, s[24:27], s65 offen sc1
L_pp_150:
    s_waitcnt vmcnt(2)
    v_xor_b32 v32, v4, v32
    v_xor_b32 v34, v4, v34
    v_or_b32 v28, v32, v34
    v_and_b32 v28, 0xfff, v28
    v_cmp_ne_u32 vcc, 0, v28
    s_nop 0
    s_cbranch_vccz L_ppk_152
    buffer_load_dwordx2 v[32:33], v20, s[24:27], s64 offen sc1
    buffer_load_dwordx2 v[34:35], v20, s[24:27], s65 offen sc1
    s_waitcnt vmcnt(2)
    v_xor_b32 v36, v4, v36
    v_xor_b32 v38, v4, v38
    v_or_b32 v28, v36, v38
    v_and_b32 v28, 0xfff, v28
    v_cmp_ne_u32 vcc, 0, v28
    s_nop 0
    s_cbranch_vccz L_ppk_153
    buffer_load_dwordx2 v[36:37], v20, s[24:27], s64 offen sc1
    buffer_load_dwordx2 v[38:39], v20, s[24:27], s65 offen sc1
    s_add_u32 s7, s7, 1
    s_cmp_lt_u32 s7, 131072
    s_cbranch_scc1 L_pp_150
    s_waitcnt vmcnt(0)
L_ppk_152:
    v_pk_add_f32 v[24:25], v[32:33], v[34:35]
    s_branch L_ppd_151
L_ppk_153:
    v_pk_add_f32 v[24:25], v[36:37], v[38:39]
L_ppd_151:
    s_nop 1
    v_permlane16_swap_b32 v24, v25
    v_add_f32 v24, v24, v25
    v_mov_b32 v25, v24
    s_nop 1
    v_permlane32_swap_b32 v24, v25
    v_add_f32 v24, v24, v25
    v_cvt_pk_bf16_f32 v24, v24, v24
    v_and_b32 v24, 0xffff0000, v24
    v_mul_f32 v24, v17, v24
    v_cvt_pk_bf16_f32 v24, v24, v24
    v_and_b32 v24, 0xffff0000, v24
    v_add_f32 v16, v16, v24
    v_cvt_pk_bf16_f32 v16, v16, v16
    v_and_b32 v16, 0xffff0000, v16
    v_sub_f32 v26, v16, v2
    v_mul_f32 v24, v26, v18
    v_mul_f32 v27, v26, v26
    v_add_f32_dpp v26, v26, v26 row_ror:1 row_mask:0xf bank_mask:0xf
    v_mov_b32_dpp v25, v24 quad_perm:[1,1,3,3] row_mask:0xf bank_mask:0xf
    v_add_f32_dpp v27, v27, v27 row_ror:1 row_mask:0xf bank_mask:0xf
    v_cvt_pk_bf16_f32 v24, v24, v25
    s_cmp_eq_u32 s6, 3
    s_cbranch_scc0 L_is_154
    s_and_b64 exec, s[88:89], 0x55555555
    buffer_store_dword v24, v21, s[24:27], s20 offen
    s_mov_b64 exec, s[88:89]
    v_add_f32_dpp v26, v26, v26 row_ror:2 row_mask:0xf bank_mask:0xf
    v_add_f32_dpp v27, v27, v27 row_ror:2 row_mask:0xf bank_mask:0xf
    s_nop 0
    v_add_f32_dpp v26, v26, v26 row_ror:4 row_mask:0xf bank_mask:0xf
    v_add_f32_dpp v27, v27, v27 row_ror:4 row_mask:0xf bank_mask:0xf
    s_nop 0
    v_add_f32_dpp v26, v26, v26 row_ror:8 row_mask:0xf bank_mask:0xf
    v_add_f32_dpp v27, v27, v27 row_ror:8 row_mask:0xf bank_mask:0xf
    s_and_b64 exec, s[88:89], 0x10001
    buffer_store_dwordx2 v[26:27], v22, s[24:27], s21 offen
L_isd_155:
    s_mov_b64 exec, s[88:89]
    s_and_b32 s28, s5, 7
    s_cmp_lg_u32 s28, s4
    s_cbranch_scc1 L_oend
    v_and_b32 v5, 15, v0
    v_lshlrev_b32 v5, 3, v5
    s_mov_b32 s7, 0
L_pl_156:
    buffer_load_dwordx2 v[24:25], v5, s[24:27], s19 offen sc1
    s_waitcnt vmcnt(0)
    v_xor_b32 v6, s35, v25
    v_cmp_ne_u32 vcc, 0, v6
    s_nop 0
    s_cbranch_vccz L_pld_157
    s_sleep 1
    s_add_u32 s7, s7, 1
    s_cmp_lt_u32 s7, 131072
    s_cbranch_scc1 L_pl_156
L_pld_157:
    v_perm_b32 v19, v24, v24, v19
    s_mov_b32 s7, 0
    buffer_load_dwordx2 v[32:33], v20, s[24:27], s66 offen sc1
    buffer_load_dwordx2 v[34:35], v20, s[24:27], s67 offen sc1
    buffer_load_dwordx2 v[36:37], v20, s[24:27], s66 offen sc1
    buffer_load_dwordx2 v[38:39], v20, s[24:27], s67 offen sc1
L_pp_158:
    s_waitcnt vmcnt(2)
    v_xor_b32 v32, v4, v32
    v_xor_b32 v34, v4, v34
    v_or_b32 v28, v32, v34
    v_and_b32 v28, 0xfff, v28
    v_cmp_ne_u32 vcc, 0, v28
    s_nop 0
    s_cbranch_vccz L_ppk_160
    buffer_load_dwordx2 v[32:33], v20, s[24:27], s66 offen sc1
    buffer_load_dwordx2 v[34:35], v20, s[24:27], s67 offen sc1
    s_waitcnt vmcnt(2)
    v_xor_b32 v36, v4, v36
    v_xor_b32 v38, v4, v38
    v_or_b32 v28, v36, v38
    v_and_b32 v28, 0xfff, v28
    v_cmp_ne_u32 vcc, 0, v28
    s_nop 0
    s_cbranch_vccz L_ppk_161
    buffer_load_dwordx2 v[36:37], v20, s[24:27], s66 offen sc1
    buffer_load_dwordx2 v[38:39], v20, s[24:27], s67 offen sc1
    s_add_u32 s7, s7, 1
    s_cmp_lt_u32 s7, 131072
    s_cbranch_scc1 L_pp_158
    s_waitcnt vmcnt(0)
L_ppk_160:
    v_pk_add_f32 v[24:25], v[32:33], v[34:35]
    s_branch L_ppd_159
L_ppk_161:
    v_pk_add_f32 v[24:25], v[36:37], v[38:39]
L_ppd_159:
    s_nop 1
    v_permlane16_swap_b32 v24, v25
    v_add_f32 v24, v24, v25
    v_mov_b32 v25, v24
    s_nop 1
    v_permlane32_swap_b32 v24, v25
    v_add_f32 v24, v24, v25
    v_cvt_pk_bf16_f32 v24, v24, v24
    v_and_b32 v24, 0xffff0000, v24
    v_mul_f32 v24, v19, v24
    v_cvt_pk_bf16_f32 v24, v24, v24
    v_and_b32 v24, 0xffff0000, v24
    v_add_f32 v24, v16, v24
    s_nop 1
    v_mov_b32_dpp v25, v24 quad_perm:[1,1,3,3] row_mask:0xf bank_mask:0xf
    v_cvt_pk_bf16_f32 v24, v24, v25
    s_and_b64 exec, s[88:89], 0x55555555
    buffer_store_dword v24, v21, s[12:15], s23 offen
L_oend:
    s_cbranch_execz L_ret_o
    s_or_b32 s28, s22, s4
    s_cbranch_scc1 L_svc_end
    s_and_b64 exec, s[88:89], 0x1
    v_mov_b32 v24, s35
    s_mov_b32 s28, 786432
    buffer_store_dword v24, v1, s[24:27], s28 offen
L_svc_end:
    s_waitcnt lgkmcnt(0)
    s_endpgm
L_is_19:
    buffer_store_dwordx4 v[10:13], v4, s[24:27], s28 offen sc1
    s_branch L_isd_20
L_is_102:
    buffer_store_dwordx4 v[40:43], v1, s[24:27], s29 offen sc1
    s_branch L_isd_103
L_is_124:
    buffer_store_dwordx2 v[8:9], v7, s[24:27], s64 offen sc1
    s_branch L_isd_125
L_is_154:
    s_and_b64 exec, s[88:89], 0x55555555
    buffer_store_dword v24, v21, s[24:27], s20 offen sc1
    s_mov_b64 exec, s[88:89]
    v_add_f32_dpp v26, v26, v26 row_ror:2 row_mask:0xf bank_mask:0xf
    v_add_f32_dpp v27, v27, v27 row_ror:2 row_mask:0xf bank_mask:0xf
    s_nop 0
    v_add_f32_dpp v26, v26, v26 row_ror:4 row_mask:0xf bank_mask:0xf
    v_add_f32_dpp v27, v27, v27 row_ror:4 row_mask:0xf bank_mask:0xf
    s_nop 0
    v_add_f32_dpp v26, v26, v26 row_ror:8 row_mask:0xf bank_mask:0xf
    v_add_f32_dpp v27, v27, v27 row_ror:8 row_mask:0xf bank_mask:0xf
    s_and_b64 exec, s[88:89], 0x10001
    buffer_store_dwordx2 v[26:27], v22, s[24:27], s21 offen sc1
    s_branch L_isd_155
L_exit:
    s_endpgm
.section .rodata,"a"
.p2align 6
.amdhsa_kernel adaLN_cond__gqa_block_cached__glu_gated_swiglu__decode_kernel
  .amdhsa_next_free_vgpr 168
  .amdhsa_next_free_sgpr 102
  .amdhsa_accum_offset 168
  .amdhsa_group_segment_fixed_size 0
  .amdhsa_kernarg_size 112
  .amdhsa_float_denorm_mode_32 3
  .amdhsa_user_sgpr_count 2
  .amdhsa_user_sgpr_kernarg_segment_ptr 1
  .amdhsa_system_sgpr_workgroup_id_x 1
.end_amdhsa_kernel
```
